```python
import torch

def _softmax(x, axis=-1):
    return torch.softmax(x, dim=axis)
def _gelu(x):
    return torch.nn.functional.gelu(x, approximate="tanh")
def _silu(x):
    return torch.nn.functional.silu(x)
def _sigmoid(x):
    return torch.sigmoid(x)
def _layernorm(x, axis=-1, eps=1e-5):
    m = x.mean(dim=axis, keepdim=True)
    v = x.var(dim=axis, keepdim=True, unbiased=False)
    return (x - m) / torch.sqrt(v + eps)
def _scatter_add(tgt, idx, src, axis=0):
    return tgt.clone().index_add_(axis, idx, src)
def _segment_sum(src, seg, n):
    out = torch.zeros((n,) + src.shape[1:], dtype=src.dtype)
    return out.index_add_(0, seg, src)
def _pad(x, pw):
    flat = tuple(v for pair in reversed(pw) for v in pair)
    return torch.nn.functional.pad(x, flat)

kernel_name = 'gated_mix__linear_attn_block__ssm_conv_s4d__prompt'

def setup_inputs():

    _w = (lambda a: (lambda t: t.to(torch.bfloat16) if t.is_floating_point() else t)(torch.as_tensor(a)))
    def _A_setup():
        B, S, D = 1, 2048, 1024
        return {
            "x": _w((lambda *s: torch.randn(*s, dtype=torch.bfloat16) * 0.05)(B, S, D)),
            "wqkv": _w((lambda *s: torch.randn(*s, dtype=torch.bfloat16) * 0.8)(D, 3 * D)),
            "wo": _w((lambda *s: torch.randn(*s, dtype=torch.bfloat16) * 0.05)(D, D)),
        }
    _A_in = _A_setup()

    def _B_setup():
        Bsz, L, D, N = 1, 2048, 1024, 128
        return {
            "u": _w((lambda *s: torch.randn(*s, dtype=torch.bfloat16) * 0.05)(Bsz, L, D)),
            "log_A_real": _w((lambda *s: torch.randn(*s, dtype=torch.bfloat16) * 3.2)(D, N) * 0.5),
            "A_imag": _w((lambda *s: torch.randn(*s, dtype=torch.bfloat16) * 0.05)(D, N) * 3.14),
            "C_real": _w((lambda *s: torch.randn(*s, dtype=torch.bfloat16) * 0.8)(D, N) / N ** 0.5),
            "C_imag": _w((lambda *s: torch.randn(*s, dtype=torch.bfloat16) * 0.8)(D, N) / N ** 0.5),
            "log_dt": _w((lambda *s: torch.randn(*s, dtype=torch.bfloat16) * 0.05)(D) * 0.5 - 4.0),
            "D_skip": _w((lambda *s: torch.randn(*s, dtype=torch.bfloat16) * 0.1)(D)),
        }
    _B_in = _B_setup()

    return {
        "A_x": _A_in["x"],
        "A_wqkv": _A_in["wqkv"],
        "A_wo": _A_in["wo"],
        "B_u": _B_in["u"],
        "B_log_A_real": _B_in["log_A_real"],
        "B_A_imag": _B_in["A_imag"],
        "B_C_real": _B_in["C_real"],
        "B_C_imag": _B_in["C_imag"],
        "B_log_dt": _B_in["log_dt"],
        "B_D_skip": _B_in["D_skip"],
        "gate_w": _w((lambda *s: torch.randn(*s, dtype=torch.bfloat16) * 0.05)(1024) * 16.0),
    }

def reference(A_x, A_wqkv, A_wo, B_u, B_log_A_real, B_A_imag, B_C_real, B_C_imag, B_log_dt, B_D_skip, gate_w):
    def _A_ref(x, wqkv, wo):
        B, S, D = x.shape
        H = 32; Dh = D // H
        qkv = (lambda x, *d: x.permute(*d))((x @ wqkv).reshape(B, S, 3, H, Dh), 2, 0, 3, 1, 4)
        q, k, v = qkv[0], qkv[1], qkv[2]
        phi = lambda t: torch.where(t > 0, t + 1, torch.exp(t)) + 1e-6
        pq, pk = phi(q), phi(k)
        kv = torch.einsum("bhsd,bhse->bhde", pk, v)
        z = torch.einsum("bhsd->bhd", pk)
        num = torch.einsum("bhqd,bhde->bhqe", pq, kv)
        den = torch.einsum("bhqd,bhd->bhq", pq, z)[..., None] + 1e-6
        o = num / den
        return (lambda x, *d: x.permute(*d))(o, 0, 2, 1, 3).reshape(B, S, D) @ wo

    def _B_ref(u, log_A_real, A_imag, C_real, C_imag, log_dt, D_skip):
        L = u.shape[1]
        dt = torch.exp(log_dt)
        A = -torch.exp(log_A_real) + 1j * A_imag
        C = (C_real + 1j * C_imag) * dt[:, None]
        pos = (lambda x, dt: x.to(dt))(torch.arange(L), log_dt.dtype)
        P = torch.exp((A * dt[:, None])[:, :, None] * pos[None, None, :])
        K = 2.0 * torch.einsum("dn,dnl->dl", C, P).real
        L2 = 2 * L
        u_t = (lambda x, *d: x.permute(*d))(u, 0, 2, 1)
        Kf = (lambda x, *a, **k: torch.fft.rfft(x.float(), *a, **k))(K, L2)
        Uf = (lambda x, *a, **k: torch.fft.rfft(x.float(), *a, **k))(u_t, L2)
        y = (lambda x, *a, **k: torch.fft.irfft(x, *a, **k).to(torch.bfloat16))(Uf * Kf[None, :, :], L2)[:, :, :L]
        y = (lambda x, *d: x.permute(*d))(y, 0, 2, 1)
        return y + u * D_skip[None, None, :]

    x = A_x
    g = _sigmoid((x * gate_w).sum(-1, keepdims=True))
    a = _A_ref(x, A_wqkv, A_wo)
    b = _B_ref(x, B_log_A_real, B_A_imag, B_C_real, B_C_imag, B_log_dt, B_D_skip)
    return g * a + (1 - g) * b
```

```asm
; @launch grid=(256,1,1) block=(512,1,1) lds=163840
.amdgcn_target "amdgcn-amd-amdhsa--gfx950"
.text
.globl gated_mix__linear_attn_block__ssm_conv_s4d__prompt_kernel
.p2align 8
.type gated_mix__linear_attn_block__ssm_conv_s4d__prompt_kernel,@function
gated_mix__linear_attn_block__ssm_conv_s4d__prompt_kernel:
  s_cmp_ge_u32 s2, 256
  s_cbranch_scc1 L_end
  s_load_dwordx16 s[64:79], s[0:1], 0
  s_load_dwordx8 s[80:87], s[0:1], 64
  s_load_dwordx4 s[88:91], s[0:1], 96
  s_memrealtime s[92:93]
  s_getpc_b64 s[98:99]
  v_lshlrev_b32 v1, 7, v0
  v_min_u32 v1, 0x8cc4, v1
  global_load_dword v255, v1, s[98:99]
  v_lshrrev_b32 v1, 6, v0
  v_and_b32 v0, 63, v0
  v_readfirstlane_b32 s24, v1
  s_and_b32 s25, s2, 7
  s_lshr_b32 s26, s2, 3
  s_and_b32 s27, s25, 1
  s_lshl_b32 s27, s27, 3
  s_and_b32 s3, s26, 7
  s_add_u32 s27, s27, s3
  s_lshr_b32 s28, s25, 1
  s_lshl_b32 s28, s28, 2
  s_lshr_b32 s3, s26, 3
  s_add_u32 s28, s28, s3
  s_lshl_b32 s29, s25, 5
  s_add_u32 s29, s29, s26
  s_lshr_b32 s30, s25, 1
  s_lshl_b32 s30, s30, 2
  s_and_b32 s3, s26, 3
  s_add_u32 s30, s30, s3
  s_and_b32 s31, s25, 1
  s_lshl_b32 s31, s31, 3
  s_lshr_b32 s3, s26, 2
  s_add_u32 s31, s31, s3
  s_mov_b32 s56, 1069066811
  s_mov_b32 s57, 1042479491
  s_waitcnt lgkmcnt(0)
  s_mov_b32 s4, s64
  s_and_b32 s5, s65, 0xffff
  s_mov_b32 s6, 4194304
  s_mov_b32 s7, 0x20000
  s_mov_b32 s8, s66
  s_and_b32 s9, s67, 0xffff
  s_mov_b32 s10, 6291456
  s_mov_b32 s11, 0x20000
  s_mov_b32 s12, s90
  s_and_b32 s13, s91, 0xffff
  s_mov_b32 s14, 33554432
  s_mov_b32 s15, 0x20000
  s_mov_b32 s16, s68
  s_and_b32 s17, s69, 0xffff
  s_mov_b32 s18, 2097152
  s_mov_b32 s19, 0x20000
  s_mov_b32 s20, s86
  s_and_b32 s21, s87, 0xffff
  s_mov_b32 s22, 4194304
  s_mov_b32 s23, 0x20000
  s_cmp_ge_u32 s24, 4
  s_cbranch_scc1 L_aux
  s_lshl_b32 s61, s29, 2
  s_add_u32 s61, s61, s24
  s_lshl_b32 s3, s61, 8
  v_lshl_add_u32 v14, v0, 2, s3
  global_load_dword v34, v14, s[72:73]
  global_load_dword v35, v14, s[74:75]
  global_load_dword v36, v14, s[76:77]
  global_load_dword v37, v14, s[78:79]
  s_lshl_b32 s3, s61, 1
  v_mov_b32 v15, s3
  global_load_ushort v38, v15, s[80:81]
  global_load_ushort v39, v15, s[82:83]
  v_lshlrev_b32 v15, 5, v0
  global_load_dwordx4 v[232:235], v15, s[84:85]
  global_load_dwordx4 v[236:239], v15, s[84:85] offset:16
  v_mov_b32 v212, 0
  v_mov_b32 v213, 0
  s_or_b32 s3, s24, s2
  s_cmp_lg_u32 s3, 0
  s_cbranch_scc1 L_nononce_1
  s_or_b32 s3, s92, 1
  v_mov_b32 v216, s3
  v_mov_b32 v217, s93
  s_mov_b64 exec, 1
  global_store_dwordx2 v212, v[216:217], s[88:89] sc1
  s_mov_b64 exec, -1
L_nononce_1:
  s_branch L_x
L_aux:
  s_sub_u32 s32, s24, 4
  v_lshrrev_b32 v2, 3, v0
  v_and_b32 v3, 7, v0
  v_lshrrev_b32 v4, 4, v0
  s_lshl_b32 s3, s27, 7
  s_lshl_b32 s33, s32, 5
  s_add_u32 s3, s3, s33
  v_add_u32 v5, s3, v2
  v_lshlrev_b32 v5, 11, v5
  v_or_b32 v6, 0, v4
  v_xor_b32 v6, v6, v3
  v_lshl_add_u32 v72, v6, 4, v5
  v_or_b32 v6, 4, v4
  v_xor_b32 v6, v6, v3
  v_lshl_add_u32 v73, v6, 4, v5
  v_add_u32 v73, 15360, v73
  v_or_b32 v6, 0, v4
  v_xor_b32 v6, v6, v3
  v_lshl_add_u32 v74, v6, 4, v5
  v_add_u32 v74, 30720, v74
  v_or_b32 v6, 4, v4
  v_xor_b32 v6, v6, v3
  v_lshl_add_u32 v75, v6, 4, v5
  v_add_u32 v75, 46080, v75
  s_lshl_b32 s3, s32, 4
  v_add_u32 v5, s3, v2
  s_movk_i32 s3, 6144
  v_mul_lo_u32 v5, v5, s3
  s_lshl_b32 s3, s28, 7
  v_add_u32 v5, s3, v5
  v_bfe_u32 v6, v0, 4, 1
  v_lshlrev_b32 v6, 1, v6
  v_xor_b32 v6, v6, v3
  v_lshl_add_u32 v76, v6, 4, v5
  v_xor_b32 v6, 4, v6
  v_lshl_add_u32 v77, v6, 4, v5
  v_add_u32 v77, 48128, v77
  v_add_u32 v78, 2048, v76
  v_add_u32 v79, 2048, v77
  v_add_u32 v80, 4096, v76
  v_add_u32 v81, 4096, v77
  s_lshl_b32 s34, s32, 12
  s_lshl_b32 s35, s32, 11
  s_and_b32 s36, s26, 7
  s_lshl_b32 s36, s36, 1
  s_lshr_b32 s37, s26, 3
  s_lshl_b32 s37, s37, 2
  s_add_u32 s36, s36, s37
  s_lshr_b32 s98, s25, 1
  s_add_u32 s37, s36, 0
  s_and_b32 s37, s37, 15
  s_lshl_b32 s38, s37, 7
  s_add_u32 m0, s34, 81920
  s_mul_i32 s39, s37, 393216
  buffer_load_dwordx4 v72, s[4:7], s38 offen offset:0 lds
  buffer_load_dwordx4 v73, s[4:7], s38 offen offset:1024 lds
  buffer_load_dwordx4 v74, s[4:7], s38 offen offset:2048 lds
  buffer_load_dwordx4 v75, s[4:7], s38 offen offset:3072 lds
  s_add_u32 m0, s35, 98304
  s_nop 0
  buffer_load_dwordx4 v76, s[8:11], s39 offen offset:0 lds
  buffer_load_dwordx4 v77, s[8:11], s39 offen offset:1024 lds
  s_add_u32 m0, s35, 106496
  s_nop 0
  buffer_load_dwordx4 v78, s[8:11], s39 offen offset:0 lds
  buffer_load_dwordx4 v79, s[8:11], s39 offen offset:1024 lds
  s_add_u32 m0, s35, 114688
  s_nop 0
  buffer_load_dwordx4 v80, s[8:11], s39 offen offset:0 lds
  buffer_load_dwordx4 v81, s[8:11], s39 offen offset:1024 lds
  s_add_u32 s37, s36, 1
  s_and_b32 s37, s37, 15
  s_lshl_b32 s38, s37, 7
  s_add_u32 m0, s34, 0
  s_mul_i32 s39, s37, 393216
  buffer_load_dwordx4 v72, s[4:7], s38 offen offset:0 lds
  buffer_load_dwordx4 v73, s[4:7], s38 offen offset:1024 lds
  buffer_load_dwordx4 v74, s[4:7], s38 offen offset:2048 lds
  buffer_load_dwordx4 v75, s[4:7], s38 offen offset:3072 lds
  s_add_u32 m0, s35, 16384
  s_nop 0
  buffer_load_dwordx4 v76, s[8:11], s39 offen offset:0 lds
  buffer_load_dwordx4 v77, s[8:11], s39 offen offset:1024 lds
  s_add_u32 m0, s35, 24576
  s_nop 0
  buffer_load_dwordx4 v78, s[8:11], s39 offen offset:0 lds
  buffer_load_dwordx4 v79, s[8:11], s39 offen offset:1024 lds
  s_add_u32 m0, s35, 32768
  s_nop 0
  buffer_load_dwordx4 v80, s[8:11], s39 offen offset:0 lds
  buffer_load_dwordx4 v81, s[8:11], s39 offen offset:1024 lds
  v_lshlrev_b32 v6, 2, v0
  v_add_u32 v6, 161792, v6
  v_mov_b32 v7, 0
  ds_write_b32 v6, v7
  v_and_b32 v2, 7, v0
  s_lshl_b32 s3, s32, 1
  v_xor_b32 v2, s3, v2
  v_lshlrev_b32 v3, 8, v0
  v_lshl_add_u32 v82, v2, 4, v3
  v_xor_b32 v83, 16, v82
  v_lshlrev_b32 v84, 4, v0
  s_add_u32 s33, s36, s98
  s_and_b32 s33, s33, 15
  s_lshl_b32 s61, s33, 18
  s_lshl_b32 s3, s32, 16
  s_add_u32 s61, s61, s3
  s_lshl_b32 s3, s27, 10
  s_add_u32 s61, s61, s3
  s_add_u32 s61, s61, 20971520
  v_lshrrev_b32 v219, 3, v0
  s_lshl_b32 s3, s32, 3
  v_add_u32 v219, s3, v219
  v_lshlrev_b32 v219, 11, v219
  v_bfe_u32 v220, v0, 4, 2
  v_lshlrev_b32 v220, 1, v220
  v_and_b32 v221, 7, v0
  v_xor_b32 v220, v220, v221
  v_lshl_add_u32 v241, v220, 4, v219
  s_and_b32 s3, s30, 1
  s_lshl_b32 s3, s3, 20
  s_lshl_b32 s62, s31, 7
  s_add_u32 s62, s62, s3
  s_lshl_b32 s63, s32, 10
  s_mov_b32 s94, 0x05040100
  s_mov_b32 s95, 0x07060302
  v_mov_b32 v210, 161792
  v_mov_b32 v211, 1
  v_mov_b32 v212, 0
  v_mov_b32 v214, 0
  v_mov_b32 v215, 0
  s_cmp_lg_u32 s32, 0
  s_cbranch_scc1 L_nononce_2
  s_mov_b64 exec, 1
  global_load_dwordx2 v[214:215], v212, s[88:89] sc1
  s_mov_b64 exec, -1
L_nononce_2:
  s_add_u32 s37, s36, 2
  s_and_b32 s37, s37, 15
  s_lshl_b32 s38, s37, 7
  s_add_u32 m0, s34, 40960
  s_mul_i32 s39, s37, 393216
  buffer_load_dwordx4 v72, s[4:7], s38 offen offset:0 lds
  buffer_load_dwordx4 v73, s[4:7], s38 offen offset:1024 lds
  buffer_load_dwordx4 v74, s[4:7], s38 offen offset:2048 lds
  buffer_load_dwordx4 v75, s[4:7], s38 offen offset:3072 lds
  s_add_u32 m0, s35, 57344
  s_nop 0
  buffer_load_dwordx4 v76, s[8:11], s39 offen offset:0 lds
  buffer_load_dwordx4 v77, s[8:11], s39 offen offset:1024 lds
  s_add_u32 m0, s35, 65536
  s_nop 0
  buffer_load_dwordx4 v78, s[8:11], s39 offen offset:0 lds
  buffer_load_dwordx4 v79, s[8:11], s39 offen offset:1024 lds
  s_add_u32 m0, s35, 73728
  s_nop 0
  buffer_load_dwordx4 v80, s[8:11], s39 offen offset:0 lds
  buffer_load_dwordx4 v81, s[8:11], s39 offen offset:1024 lds
  s_waitcnt vmcnt(20)
  s_waitcnt lgkmcnt(0)
  s_barrier
  s_cmp_lg_u32 s98, 0
  s_cbranch_scc1 L_nou_3
  v_add_u32 v82, 81920, v82
  v_add_u32 v83, 81920, v83
  ds_read_b64 v[96:97], v82 offset:0
  ds_read_b64 v[98:99], v82 offset:128
  ds_read_b64 v[100:101], v82 offset:8
  ds_read_b64 v[102:103], v82 offset:136
  ds_read_b64 v[104:105], v83 offset:0
  ds_read_b64 v[106:107], v83 offset:128
  ds_read_b64 v[108:109], v83 offset:8
  ds_read_b64 v[110:111], v83 offset:136
L_nou_3:
  s_mul_i32 s97, s32, 8704
  s_add_u32 s97, s97, 122880
  v_bfe_u32 v220, v0, 1, 1
  v_bfe_u32 v221, v0, 2, 2
  v_lshrrev_b32 v222, 4, v0
  v_lshlrev_b32 v223, 4, v222
  v_add_u32 v223, 392, v223
  v_lshlrev_b32 v220, 3, v220
  v_sub_u32 v223, v223, v220
  v_lshlrev_b32 v221, 7, v221
  v_sub_u32 v223, v223, v221
  v_and_b32 v220, 1, v0
  v_lshlrev_b32 v221, 5, v220
  s_mul_i32 s3, s32, 9216
  s_add_u32 s3, s3, 0
  v_mul_u32_u24 v220, 4608, v220
  v_add_u32 v220, s3, v220
  v_add_u32 v224, 0, v223
  v_lshrrev_b32 v219, 2, v224
  v_and_or_b32 v219, v219, 64, v221
  v_xad_u32 v224, v224, v219, v220
  v_add_u32 v225, 8, v223
  v_lshrrev_b32 v219, 2, v225
  v_and_or_b32 v219, v219, 64, v221
  v_xad_u32 v225, v225, v219, v220
  v_add_u32 v226, 64, v223
  v_lshrrev_b32 v219, 2, v226
  v_and_or_b32 v219, v219, 64, v221
  v_xad_u32 v226, v226, v219, v220
  v_add_u32 v227, 72, v223
  v_lshrrev_b32 v219, 2, v227
  v_and_or_b32 v219, v219, 64, v221
  v_xad_u32 v227, v227, v219, v220
  v_add_u32 v228, 128, v223
  v_lshrrev_b32 v219, 2, v228
  v_and_or_b32 v219, v219, 64, v221
  v_xad_u32 v228, v228, v219, v220
  v_add_u32 v229, 136, v223
  v_lshrrev_b32 v219, 2, v229
  v_and_or_b32 v219, v219, 64, v221
  v_xad_u32 v229, v229, v219, v220
  v_add_u32 v230, 192, v223
  v_lshrrev_b32 v219, 2, v230
  v_and_or_b32 v219, v219, 64, v221
  v_xad_u32 v230, v230, v219, v220
  v_add_u32 v231, 200, v223
  v_lshrrev_b32 v219, 2, v231
  v_and_or_b32 v219, v219, 64, v221
  v_xad_u32 v231, v231, v219, v220
  v_add_u32 v232, 256, v223
  v_lshrrev_b32 v219, 2, v232
  v_and_or_b32 v219, v219, 64, v221
  v_xad_u32 v232, v232, v219, v220
  v_add_u32 v233, 264, v223
  v_lshrrev_b32 v219, 2, v233
  v_and_or_b32 v219, v219, 64, v221
  v_xad_u32 v233, v233, v219, v220
  v_add_u32 v234, 320, v223
  v_lshrrev_b32 v219, 2, v234
  v_and_or_b32 v219, v219, 64, v221
  v_xad_u32 v234, v234, v219, v220
  v_add_u32 v235, 328, v223
  v_lshrrev_b32 v219, 2, v235
  v_and_or_b32 v219, v219, 64, v221
  v_xad_u32 v235, v235, v219, v220
  v_add_u32 v236, 384, v223
  v_lshrrev_b32 v219, 2, v236
  v_and_or_b32 v219, v219, 64, v221
  v_xad_u32 v236, v236, v219, v220
  v_add_u32 v237, 392, v223
  v_lshrrev_b32 v219, 2, v237
  v_and_or_b32 v219, v219, 64, v221
  v_xad_u32 v237, v237, v219, v220
  v_add_u32 v238, 448, v223
  v_lshrrev_b32 v219, 2, v238
  v_and_or_b32 v219, v219, 64, v221
  v_xad_u32 v238, v238, v219, v220
  v_add_u32 v239, 456, v223
  v_lshrrev_b32 v219, 2, v239
  v_and_or_b32 v219, v219, 64, v221
  v_xad_u32 v239, v239, v219, v220
  v_bfe_u32 v219, v0, 1, 3
  v_add_u32 v219, v219, v222
  v_lshl_add_u32 v240, v219, 4, s97
  v_and_b32 v219, 1, v0
  v_xor_b32 v219, 1, v219
  v_mul_u32_u24 v219, 4480, v219
  v_add_u32 v240, v240, v219
  s_waitcnt vmcnt(10)
  s_waitcnt lgkmcnt(0)
  s_barrier
  s_cmp_lg_u32 s98, 1
  s_cbranch_scc1 L_nou_4
  ds_read_b64 v[96:97], v82 offset:0
  ds_read_b64 v[98:99], v82 offset:128
  ds_read_b64 v[100:101], v82 offset:8
  ds_read_b64 v[102:103], v82 offset:136
  ds_read_b64 v[104:105], v83 offset:0
  ds_read_b64 v[106:107], v83 offset:128
  ds_read_b64 v[108:109], v83 offset:8
  ds_read_b64 v[110:111], v83 offset:136
L_nou_4:
  s_add_u32 s37, s36, 3
  s_and_b32 s37, s37, 15
  s_lshl_b32 s38, s37, 7
  s_add_u32 m0, s34, 81920
  s_mul_i32 s39, s37, 393216
  buffer_load_dwordx4 v72, s[4:7], s38 offen offset:0 lds
  buffer_load_dwordx4 v73, s[4:7], s38 offen offset:1024 lds
  buffer_load_dwordx4 v74, s[4:7], s38 offen offset:2048 lds
  buffer_load_dwordx4 v75, s[4:7], s38 offen offset:3072 lds
  s_add_u32 m0, s35, 98304
  s_nop 0
  buffer_load_dwordx4 v76, s[8:11], s39 offen offset:0 lds
  buffer_load_dwordx4 v77, s[8:11], s39 offen offset:1024 lds
  s_add_u32 m0, s35, 106496
  s_nop 0
  buffer_load_dwordx4 v78, s[8:11], s39 offen offset:0 lds
  buffer_load_dwordx4 v79, s[8:11], s39 offen offset:1024 lds
  s_add_u32 m0, s35, 114688
  s_nop 0
  buffer_load_dwordx4 v80, s[8:11], s39 offen offset:0 lds
  buffer_load_dwordx4 v81, s[8:11], s39 offen offset:1024 lds
  s_waitcnt vmcnt(10)
  s_waitcnt lgkmcnt(0)
  s_barrier
  s_cmp_lg_u32 s98, 2
  s_cbranch_scc1 L_nou_5
  ds_read_b64 v[96:97], v82 offset:40960
  ds_read_b64 v[98:99], v82 offset:41088
  ds_read_b64 v[100:101], v82 offset:40968
  ds_read_b64 v[102:103], v82 offset:41096
  ds_read_b64 v[104:105], v83 offset:40960
  ds_read_b64 v[106:107], v83 offset:41088
  ds_read_b64 v[108:109], v83 offset:40968
  ds_read_b64 v[110:111], v83 offset:41096
L_nou_5:
  s_cmp_lg_u32 s32, 0
  s_cbranch_scc1 L_nononce_6
  s_mov_b32 s58, 0
L_npoll_7:
  v_readfirstlane_b32 s3, v214
  s_add_u32 s58, s58, 1
  s_cmp_lg_u32 s3, 0
  s_cbranch_scc1 L_nok_8
  global_load_dwordx2 v[214:215], v212, s[88:89] sc1
  s_waitcnt vmcnt(0)
  s_cmp_lt_u32 s58, 4194304
  s_cbranch_scc1 L_npoll_7
L_nok_8:
  s_mov_b64 exec, 1
  ds_write_b64 v210, v[214:215] offset:0
  s_mov_b64 exec, -1
L_nononce_6:
  s_add_u32 s37, s36, 4
  s_and_b32 s37, s37, 15
  s_lshl_b32 s38, s37, 7
  s_add_u32 m0, s34, 0
  s_mul_i32 s39, s37, 393216
  buffer_load_dwordx4 v72, s[4:7], s38 offen offset:0 lds
  buffer_load_dwordx4 v73, s[4:7], s38 offen offset:1024 lds
  buffer_load_dwordx4 v74, s[4:7], s38 offen offset:2048 lds
  buffer_load_dwordx4 v75, s[4:7], s38 offen offset:3072 lds
  s_add_u32 m0, s35, 16384
  s_nop 0
  buffer_load_dwordx4 v76, s[8:11], s39 offen offset:0 lds
  buffer_load_dwordx4 v77, s[8:11], s39 offen offset:1024 lds
  s_add_u32 m0, s35, 24576
  s_nop 0
  buffer_load_dwordx4 v78, s[8:11], s39 offen offset:0 lds
  buffer_load_dwordx4 v79, s[8:11], s39 offen offset:1024 lds
  s_add_u32 m0, s35, 32768
  s_nop 0
  buffer_load_dwordx4 v80, s[8:11], s39 offen offset:0 lds
  buffer_load_dwordx4 v81, s[8:11], s39 offen offset:1024 lds
  s_waitcnt vmcnt(10)
  s_waitcnt lgkmcnt(0)
  s_barrier
  s_cmp_lg_u32 s98, 3
  s_cbranch_scc1 L_nou_9
  v_add_u32 v82, 81920, v82
  v_add_u32 v83, 81920, v83
  ds_read_b64 v[96:97], v82 offset:0
  ds_read_b64 v[98:99], v82 offset:128
  ds_read_b64 v[100:101], v82 offset:8
  ds_read_b64 v[102:103], v82 offset:136
  ds_read_b64 v[104:105], v83 offset:0
  ds_read_b64 v[106:107], v83 offset:128
  ds_read_b64 v[108:109], v83 offset:8
  ds_read_b64 v[110:111], v83 offset:136
L_nou_9:
  s_add_u32 s37, s36, 5
  s_and_b32 s37, s37, 15
  s_lshl_b32 s38, s37, 7
  s_add_u32 m0, s34, 40960
  s_mul_i32 s39, s37, 393216
  buffer_load_dwordx4 v72, s[4:7], s38 offen offset:0 lds
  buffer_load_dwordx4 v73, s[4:7], s38 offen offset:1024 lds
  buffer_load_dwordx4 v74, s[4:7], s38 offen offset:2048 lds
  buffer_load_dwordx4 v75, s[4:7], s38 offen offset:3072 lds
  s_add_u32 m0, s35, 57344
  s_nop 0
  buffer_load_dwordx4 v76, s[8:11], s39 offen offset:0 lds
  buffer_load_dwordx4 v77, s[8:11], s39 offen offset:1024 lds
  s_add_u32 m0, s35, 65536
  s_nop 0
  buffer_load_dwordx4 v78, s[8:11], s39 offen offset:0 lds
  buffer_load_dwordx4 v79, s[8:11], s39 offen offset:1024 lds
  s_add_u32 m0, s35, 73728
  s_nop 0
  buffer_load_dwordx4 v80, s[8:11], s39 offen offset:0 lds
  buffer_load_dwordx4 v81, s[8:11], s39 offen offset:1024 lds
  s_waitcnt vmcnt(10)
  s_waitcnt lgkmcnt(0)
  s_barrier
  s_add_u32 s37, s36, 6
  s_and_b32 s37, s37, 15
  s_lshl_b32 s38, s37, 7
  s_add_u32 m0, s34, 81920
  s_mul_i32 s39, s37, 393216
  buffer_load_dwordx4 v72, s[4:7], s38 offen offset:0 lds
  buffer_load_dwordx4 v73, s[4:7], s38 offen offset:1024 lds
  buffer_load_dwordx4 v74, s[4:7], s38 offen offset:2048 lds
  buffer_load_dwordx4 v75, s[4:7], s38 offen offset:3072 lds
  s_add_u32 m0, s35, 98304
  s_nop 0
  buffer_load_dwordx4 v76, s[8:11], s39 offen offset:0 lds
  buffer_load_dwordx4 v77, s[8:11], s39 offen offset:1024 lds
  s_add_u32 m0, s35, 106496
  s_nop 0
  buffer_load_dwordx4 v78, s[8:11], s39 offen offset:0 lds
  buffer_load_dwordx4 v79, s[8:11], s39 offen offset:1024 lds
  s_add_u32 m0, s35, 114688
  s_nop 0
  buffer_load_dwordx4 v80, s[8:11], s39 offen offset:0 lds
  buffer_load_dwordx4 v81, s[8:11], s39 offen offset:1024 lds
  s_add_u32 s60, s61, 0
  buffer_store_dwordx4 v[96:99], v84, s[12:15], s60 offen sc1
  s_add_u32 s60, s61, 16384
  buffer_store_dwordx4 v[100:103], v84, s[12:15], s60 offen sc1
  s_waitcnt vmcnt(12)
  s_waitcnt lgkmcnt(0)
  s_barrier
  s_add_u32 s37, s36, 7
  s_and_b32 s37, s37, 15
  s_lshl_b32 s38, s37, 7
  s_add_u32 m0, s34, 0
  s_mul_i32 s39, s37, 393216
  buffer_load_dwordx4 v72, s[4:7], s38 offen offset:0 lds
  buffer_load_dwordx4 v73, s[4:7], s38 offen offset:1024 lds
  buffer_load_dwordx4 v74, s[4:7], s38 offen offset:2048 lds
  buffer_load_dwordx4 v75, s[4:7], s38 offen offset:3072 lds
  s_add_u32 m0, s35, 16384
  s_nop 0
  buffer_load_dwordx4 v76, s[8:11], s39 offen offset:0 lds
  buffer_load_dwordx4 v77, s[8:11], s39 offen offset:1024 lds
  s_add_u32 m0, s35, 24576
  s_nop 0
  buffer_load_dwordx4 v78, s[8:11], s39 offen offset:0 lds
  buffer_load_dwordx4 v79, s[8:11], s39 offen offset:1024 lds
  s_add_u32 m0, s35, 32768
  s_nop 0
  buffer_load_dwordx4 v80, s[8:11], s39 offen offset:0 lds
  buffer_load_dwordx4 v81, s[8:11], s39 offen offset:1024 lds
  s_add_u32 s60, s61, 32768
  buffer_store_dwordx4 v[104:107], v84, s[12:15], s60 offen sc1
  s_add_u32 s60, s61, 49152
  buffer_store_dwordx4 v[108:111], v84, s[12:15], s60 offen sc1
  s_waitcnt vmcnt(14)
  s_waitcnt lgkmcnt(0)
  s_barrier
  s_add_u32 s37, s36, 8
  s_and_b32 s37, s37, 15
  s_lshl_b32 s38, s37, 7
  s_add_u32 m0, s34, 40960
  s_mul_i32 s39, s37, 393216
  buffer_load_dwordx4 v72, s[4:7], s38 offen offset:0 lds
  buffer_load_dwordx4 v73, s[4:7], s38 offen offset:1024 lds
  buffer_load_dwordx4 v74, s[4:7], s38 offen offset:2048 lds
  buffer_load_dwordx4 v75, s[4:7], s38 offen offset:3072 lds
  s_add_u32 m0, s35, 57344
  s_nop 0
  buffer_load_dwordx4 v76, s[8:11], s39 offen offset:0 lds
  buffer_load_dwordx4 v77, s[8:11], s39 offen offset:1024 lds
  s_add_u32 m0, s35, 65536
  s_nop 0
  buffer_load_dwordx4 v78, s[8:11], s39 offen offset:0 lds
  buffer_load_dwordx4 v79, s[8:11], s39 offen offset:1024 lds
  s_add_u32 m0, s35, 73728
  s_nop 0
  buffer_load_dwordx4 v80, s[8:11], s39 offen offset:0 lds
  buffer_load_dwordx4 v81, s[8:11], s39 offen offset:1024 lds
  s_waitcnt vmcnt(12)
  s_waitcnt lgkmcnt(0)
  s_barrier
  s_add_u32 s37, s36, 9
  s_and_b32 s37, s37, 15
  s_lshl_b32 s38, s37, 7
  s_add_u32 m0, s34, 81920
  s_mul_i32 s39, s37, 393216
  buffer_load_dwordx4 v72, s[4:7], s38 offen offset:0 lds
  buffer_load_dwordx4 v73, s[4:7], s38 offen offset:1024 lds
  buffer_load_dwordx4 v74, s[4:7], s38 offen offset:2048 lds
  buffer_load_dwordx4 v75, s[4:7], s38 offen offset:3072 lds
  s_add_u32 m0, s35, 98304
  s_nop 0
  buffer_load_dwordx4 v76, s[8:11], s39 offen offset:0 lds
  buffer_load_dwordx4 v77, s[8:11], s39 offen offset:1024 lds
  s_add_u32 m0, s35, 106496
  s_nop 0
  buffer_load_dwordx4 v78, s[8:11], s39 offen offset:0 lds
  buffer_load_dwordx4 v79, s[8:11], s39 offen offset:1024 lds
  s_add_u32 m0, s35, 114688
  s_nop 0
  buffer_load_dwordx4 v80, s[8:11], s39 offen offset:0 lds
  buffer_load_dwordx4 v81, s[8:11], s39 offen offset:1024 lds
  s_waitcnt vmcnt(10)
  s_waitcnt lgkmcnt(0)
  s_barrier
  s_add_u32 s37, s36, 10
  s_and_b32 s37, s37, 15
  s_lshl_b32 s38, s37, 7
  s_add_u32 m0, s34, 0
  s_mul_i32 s39, s37, 393216
  buffer_load_dwordx4 v72, s[4:7], s38 offen offset:0 lds
  buffer_load_dwordx4 v73, s[4:7], s38 offen offset:1024 lds
  buffer_load_dwordx4 v74, s[4:7], s38 offen offset:2048 lds
  buffer_load_dwordx4 v75, s[4:7], s38 offen offset:3072 lds
  s_add_u32 m0, s35, 16384
  s_nop 0
  buffer_load_dwordx4 v76, s[8:11], s39 offen offset:0 lds
  buffer_load_dwordx4 v77, s[8:11], s39 offen offset:1024 lds
  s_add_u32 m0, s35, 24576
  s_nop 0
  buffer_load_dwordx4 v78, s[8:11], s39 offen offset:0 lds
  buffer_load_dwordx4 v79, s[8:11], s39 offen offset:1024 lds
  s_add_u32 m0, s35, 32768
  s_nop 0
  buffer_load_dwordx4 v80, s[8:11], s39 offen offset:0 lds
  buffer_load_dwordx4 v81, s[8:11], s39 offen offset:1024 lds
  s_cmp_lg_u32 s32, 0
  s_cbranch_scc1 L_noupub_10
  s_lshl_b32 s60, s33, 8
  s_lshl_b32 s3, s27, 3
  s_add_u32 s60, s60, s3
  s_add_u32 s60, s60, 13643776
  s_mov_b64 exec, 1
  buffer_store_dwordx2 v[214:215], v212, s[12:15], s60 offen sc1
  s_mov_b64 exec, -1
L_noupub_10:
  s_waitcnt vmcnt(10)
  s_waitcnt lgkmcnt(0)
  s_barrier
  s_add_u32 s37, s36, 11
  s_and_b32 s37, s37, 15
  s_lshl_b32 s38, s37, 7
  s_add_u32 m0, s34, 40960
  s_mul_i32 s39, s37, 393216
  buffer_load_dwordx4 v72, s[4:7], s38 offen offset:0 lds
  buffer_load_dwordx4 v73, s[4:7], s38 offen offset:1024 lds
  buffer_load_dwordx4 v74, s[4:7], s38 offen offset:2048 lds
  buffer_load_dwordx4 v75, s[4:7], s38 offen offset:3072 lds
  s_add_u32 m0, s35, 57344
  s_nop 0
  buffer_load_dwordx4 v76, s[8:11], s39 offen offset:0 lds
  buffer_load_dwordx4 v77, s[8:11], s39 offen offset:1024 lds
  s_add_u32 m0, s35, 65536
  s_nop 0
  buffer_load_dwordx4 v78, s[8:11], s39 offen offset:0 lds
  buffer_load_dwordx4 v79, s[8:11], s39 offen offset:1024 lds
  s_add_u32 m0, s35, 73728
  s_nop 0
  buffer_load_dwordx4 v80, s[8:11], s39 offen offset:0 lds
  buffer_load_dwordx4 v81, s[8:11], s39 offen offset:1024 lds
  s_waitcnt vmcnt(10)
  s_waitcnt lgkmcnt(0)
  s_barrier
  s_add_u32 s37, s36, 12
  s_and_b32 s37, s37, 15
  s_lshl_b32 s38, s37, 7
  s_add_u32 m0, s34, 81920
  s_mul_i32 s39, s37, 393216
  buffer_load_dwordx4 v72, s[4:7], s38 offen offset:0 lds
  buffer_load_dwordx4 v73, s[4:7], s38 offen offset:1024 lds
  buffer_load_dwordx4 v74, s[4:7], s38 offen offset:2048 lds
  buffer_load_dwordx4 v75, s[4:7], s38 offen offset:3072 lds
  s_add_u32 m0, s35, 98304
  s_nop 0
  buffer_load_dwordx4 v76, s[8:11], s39 offen offset:0 lds
  buffer_load_dwordx4 v77, s[8:11], s39 offen offset:1024 lds
  s_add_u32 m0, s35, 106496
  s_nop 0
  buffer_load_dwordx4 v78, s[8:11], s39 offen offset:0 lds
  buffer_load_dwordx4 v79, s[8:11], s39 offen offset:1024 lds
  s_add_u32 m0, s35, 114688
  s_nop 0
  buffer_load_dwordx4 v80, s[8:11], s39 offen offset:0 lds
  buffer_load_dwordx4 v81, s[8:11], s39 offen offset:1024 lds
  s_waitcnt vmcnt(10)
  s_waitcnt lgkmcnt(0)
  s_barrier
  s_add_u32 s37, s36, 13
  s_and_b32 s37, s37, 15
  s_lshl_b32 s38, s37, 7
  s_add_u32 m0, s34, 0
  s_mul_i32 s39, s37, 393216
  buffer_load_dwordx4 v72, s[4:7], s38 offen offset:0 lds
  buffer_load_dwordx4 v73, s[4:7], s38 offen offset:1024 lds
  buffer_load_dwordx4 v74, s[4:7], s38 offen offset:2048 lds
  buffer_load_dwordx4 v75, s[4:7], s38 offen offset:3072 lds
  s_add_u32 m0, s35, 16384
  s_nop 0
  buffer_load_dwordx4 v76, s[8:11], s39 offen offset:0 lds
  buffer_load_dwordx4 v77, s[8:11], s39 offen offset:1024 lds
  s_add_u32 m0, s35, 24576
  s_nop 0
  buffer_load_dwordx4 v78, s[8:11], s39 offen offset:0 lds
  buffer_load_dwordx4 v79, s[8:11], s39 offen offset:1024 lds
  s_add_u32 m0, s35, 32768
  s_nop 0
  buffer_load_dwordx4 v80, s[8:11], s39 offen offset:0 lds
  buffer_load_dwordx4 v81, s[8:11], s39 offen offset:1024 lds
  s_waitcnt vmcnt(10)
  s_waitcnt lgkmcnt(0)
  s_barrier
  s_add_u32 s37, s36, 14
  s_and_b32 s37, s37, 15
  s_lshl_b32 s38, s37, 7
  s_add_u32 m0, s34, 40960
  s_mul_i32 s39, s37, 393216
  buffer_load_dwordx4 v72, s[4:7], s38 offen offset:0 lds
  buffer_load_dwordx4 v73, s[4:7], s38 offen offset:1024 lds
  buffer_load_dwordx4 v74, s[4:7], s38 offen offset:2048 lds
  buffer_load_dwordx4 v75, s[4:7], s38 offen offset:3072 lds
  s_add_u32 m0, s35, 57344
  s_nop 0
  buffer_load_dwordx4 v76, s[8:11], s39 offen offset:0 lds
  buffer_load_dwordx4 v77, s[8:11], s39 offen offset:1024 lds
  s_add_u32 m0, s35, 65536
  s_nop 0
  buffer_load_dwordx4 v78, s[8:11], s39 offen offset:0 lds
  buffer_load_dwordx4 v79, s[8:11], s39 offen offset:1024 lds
  s_add_u32 m0, s35, 73728
  s_nop 0
  buffer_load_dwordx4 v80, s[8:11], s39 offen offset:0 lds
  buffer_load_dwordx4 v81, s[8:11], s39 offen offset:1024 lds
  s_waitcnt vmcnt(10)
  s_waitcnt lgkmcnt(0)
  s_barrier
  s_add_u32 s37, s36, 15
  s_and_b32 s37, s37, 15
  s_lshl_b32 s38, s37, 7
  s_add_u32 m0, s34, 81920
  s_mul_i32 s39, s37, 393216
  buffer_load_dwordx4 v72, s[4:7], s38 offen offset:0 lds
  buffer_load_dwordx4 v73, s[4:7], s38 offen offset:1024 lds
  buffer_load_dwordx4 v74, s[4:7], s38 offen offset:2048 lds
  buffer_load_dwordx4 v75, s[4:7], s38 offen offset:3072 lds
  s_add_u32 m0, s35, 98304
  s_nop 0
  buffer_load_dwordx4 v76, s[8:11], s39 offen offset:0 lds
  buffer_load_dwordx4 v77, s[8:11], s39 offen offset:1024 lds
  s_add_u32 m0, s35, 106496
  s_nop 0
  buffer_load_dwordx4 v78, s[8:11], s39 offen offset:0 lds
  buffer_load_dwordx4 v79, s[8:11], s39 offen offset:1024 lds
  s_add_u32 m0, s35, 114688
  s_nop 0
  buffer_load_dwordx4 v80, s[8:11], s39 offen offset:0 lds
  buffer_load_dwordx4 v81, s[8:11], s39 offen offset:1024 lds
  s_waitcnt vmcnt(10)
  s_waitcnt lgkmcnt(0)
  s_barrier
  s_lshl_b32 s60, s29, 14
  s_lshl_b32 s3, s32, 12
  s_add_u32 s60, s60, s3
  s_add_u32 s60, s60, 20971520
  s_sub_u32 s61, s60, 8
  buffer_load_dwordx4 v[96:99], v84, s[12:15], s60 offen offset:0 sc1
  buffer_load_dwordx4 v[100:103], v84, s[12:15], s61 offen offset:0 sc1
  buffer_load_dwordx4 v[104:107], v84, s[12:15], s60 offen offset:1024 sc1
  buffer_load_dwordx4 v[108:111], v84, s[12:15], s61 offen offset:1024 sc1
  buffer_load_dwordx4 v[112:115], v84, s[12:15], s60 offen offset:2048 sc1
  buffer_load_dwordx4 v[116:119], v84, s[12:15], s61 offen offset:2048 sc1
  buffer_load_dwordx4 v[120:123], v84, s[12:15], s60 offen offset:3072 sc1
  buffer_load_dwordx4 v[124:127], v84, s[12:15], s61 offen offset:3072 sc1
  s_lshl_b32 s3, s32, 10
  s_sub_u32 s3, 3324, s3
  v_lshlrev_b32 v2, 2, v0
  v_sub_u32 v2, s3, v2
  v_add_u32 v3, 256, v2
  v_lshrrev_b32 v4, 2, v2
  v_and_b32 v4, 64, v4
  v_xor_b32 v4, v4, v2
  v_add_u32 v4, 0, v4
  v_xor_b32 v5, 32, v4
  v_lshrrev_b32 v6, 2, v3
  v_and_b32 v6, 64, v6
  v_xor_b32 v6, v6, v3
  v_add_u32 v6, 0, v6
  v_xor_b32 v7, 32, v6
  v_and_b32 v219, 31, v0
  v_lshlrev_b32 v219, 4, v219
  v_lshrrev_b32 v220, 5, v0
  v_mul_u32_u24 v220, 4608, v220
  v_add_u32 v219, v219, v220
  s_mul_i32 s3, s32, 9216
  s_add_u32 s3, s3, 4096
  v_add_u32 v219, s3, v219
  v_mov_b32 v220, 0
  v_mov_b32 v221, 0
  v_mov_b32 v222, 0
  v_mov_b32 v223, 0
  s_waitcnt vmcnt(8)
  s_waitcnt lgkmcnt(0)
  s_barrier
  s_add_u32 m0, s63, 40960
  s_add_u32 s60, s62, 0
  buffer_load_dwordx4 v241, s[16:19], s60 offen lds
  s_add_u32 m0, s63, 45056
  s_add_u32 s60, s62, 65536
  buffer_load_dwordx4 v241, s[16:19], s60 offen lds
  s_add_u32 m0, s63, 49152
  s_add_u32 s60, s62, 131072
  buffer_load_dwordx4 v241, s[16:19], s60 offen lds
  s_add_u32 m0, s63, 53248
  s_add_u32 s60, s62, 196608
  buffer_load_dwordx4 v241, s[16:19], s60 offen lds
  s_add_u32 m0, s63, 57344
  s_add_u32 s60, s62, 262144
  buffer_load_dwordx4 v241, s[16:19], s60 offen lds
  s_add_u32 m0, s63, 61440
  s_add_u32 s60, s62, 327680
  buffer_load_dwordx4 v241, s[16:19], s60 offen lds
  s_add_u32 m0, s63, 65536
  s_add_u32 s60, s62, 393216
  buffer_load_dwordx4 v241, s[16:19], s60 offen lds
  s_add_u32 m0, s63, 69632
  s_add_u32 s60, s62, 458752
  buffer_load_dwordx4 v241, s[16:19], s60 offen lds
  s_add_u32 m0, s63, 73728
  s_add_u32 s60, s62, 524288
  buffer_load_dwordx4 v241, s[16:19], s60 offen lds
  s_waitcnt lgkmcnt(0)
  s_barrier
  v_or_b32 v2, s32, v0
  v_cmp_ne_u32 vcc, 0, v2
  ds_write_b128 v219, v[220:223]
  s_waitcnt vmcnt(9)
  v_cndmask_b32 v100, 0, v100, vcc
  v_cndmask_b32 v101, 0, v101, vcc
  v_perm_b32 v128, v100, v102, s94
  v_perm_b32 v129, v100, v102, s95
  v_perm_b32 v130, v101, v103, s94
  v_perm_b32 v131, v101, v103, s95
  ds_write2st64_b32 v6, v128, v129 offset0:2 offset1:38
  ds_write2st64_b32 v6, v130, v131 offset0:74 offset1:110
  v_perm_b32 v132, v96, v98, s94
  v_perm_b32 v133, v96, v98, s95
  v_perm_b32 v134, v97, v99, s94
  v_perm_b32 v135, v97, v99, s95
  ds_write2st64_b32 v7, v132, v133 offset0:20 offset1:56
  ds_write2st64_b32 v7, v134, v135 offset0:92 offset1:128
  v_perm_b32 v136, v108, v110, s94
  v_perm_b32 v137, v108, v110, s95
  v_perm_b32 v138, v109, v111, s94
  v_perm_b32 v139, v109, v111, s95
  ds_write2st64_b32 v4, v136, v137 offset0:2 offset1:38
  ds_write2st64_b32 v4, v138, v139 offset0:74 offset1:110
  v_perm_b32 v140, v104, v106, s94
  v_perm_b32 v141, v104, v106, s95
  v_perm_b32 v142, v105, v107, s94
  v_perm_b32 v143, v105, v107, s95
  ds_write2st64_b32 v5, v140, v141 offset0:20 offset1:56
  ds_write2st64_b32 v5, v142, v143 offset0:92 offset1:128
  v_perm_b32 v144, v116, v118, s94
  v_perm_b32 v145, v116, v118, s95
  v_perm_b32 v146, v117, v119, s94
  v_perm_b32 v147, v117, v119, s95
  ds_write2st64_b32 v6, v144, v145 offset0:0 offset1:36
  ds_write2st64_b32 v6, v146, v147 offset0:72 offset1:108
  v_perm_b32 v148, v112, v114, s94
  v_perm_b32 v149, v112, v114, s95
  v_perm_b32 v150, v113, v115, s94
  v_perm_b32 v151, v113, v115, s95
  ds_write2st64_b32 v7, v148, v149 offset0:18 offset1:54
  ds_write2st64_b32 v7, v150, v151 offset0:90 offset1:126
  v_perm_b32 v152, v124, v126, s94
  v_perm_b32 v153, v124, v126, s95
  v_perm_b32 v154, v125, v127, s94
  v_perm_b32 v155, v125, v127, s95
  ds_write2st64_b32 v4, v152, v153 offset0:0 offset1:36
  ds_write2st64_b32 v4, v154, v155 offset0:72 offset1:108
  v_perm_b32 v156, v120, v122, s94
  v_perm_b32 v157, v120, v122, s95
  v_perm_b32 v158, v121, v123, s94
  v_perm_b32 v159, v121, v123, s95
  ds_write2st64_b32 v5, v156, v157 offset0:18 offset1:54
  ds_write2st64_b32 v5, v158, v159 offset0:90 offset1:126
  s_mov_b64 exec, 1
  ds_add_u32 v210, v211 offset:68
  s_mov_b64 exec, -1
  v_mov_b32 v242, v210
  v_mov_b32 v243, v211
  s_mov_b32 s58, 0
L_spin_11:
  ds_read_b32 v244, v242 offset:68
  s_waitcnt lgkmcnt(0)
  v_readfirstlane_b32 s59, v244
  s_add_u32 s58, s58, 1
  s_cmp_eq_u32 s59, 4
  s_cbranch_scc1 L_spun_12
  s_cmp_lt_u32 s58, 4194304
  s_cbranch_scc1 L_spin_11
L_spun_12:
  ds_read_b128 v[96:99], v240 offset:0
  ds_read_b64 v[128:129], v224 offset:3584
  ds_read_b64 v[130:131], v225 offset:3584
  ds_read_b128 v[100:103], v240 offset:512
  ds_read_b64 v[132:133], v224 offset:3072
  ds_read_b64 v[134:135], v225 offset:3072
  ds_read_b128 v[104:107], v240 offset:1024
  ds_read_b64 v[136:137], v224 offset:2560
  ds_read_b64 v[138:139], v225 offset:2560
  ds_read_b128 v[108:111], v240 offset:1536
  ds_read_b64 v[140:141], v224 offset:2048
  ds_read_b64 v[142:143], v225 offset:2048
  ds_read_b128 v[112:115], v240 offset:2048
  ds_read_b64 v[144:145], v224 offset:1536
  ds_read_b64 v[146:147], v225 offset:1536
  ds_read_b128 v[116:119], v240 offset:2560
  ds_read_b64 v[148:149], v224 offset:1024
  ds_read_b64 v[150:151], v225 offset:1024
  ds_read_b128 v[120:123], v240 offset:3072
  ds_read_b64 v[152:153], v224 offset:512
  ds_read_b64 v[154:155], v225 offset:512
  ds_read_b128 v[124:127], v240 offset:3584
  ds_read_b64 v[156:157], v224 offset:0
  ds_read_b64 v[158:159], v225 offset:0
  s_waitcnt lgkmcnt(0)
  v_mfma_f32_16x16x32_bf16 v[68:71], v[156:159], v[96:99], 0
  ds_read_b128 v[160:163], v240 offset:64
  v_mfma_f32_16x16x32_bf16 v[64:67], v[152:155], v[96:99], 0
  ds_read_b64 v[192:193], v226 offset:3584
  v_mfma_f32_16x16x32_bf16 v[60:63], v[148:151], v[96:99], 0
  ds_read_b64 v[194:195], v227 offset:3584
  v_mfma_f32_16x16x32_bf16 v[56:59], v[144:147], v[96:99], 0
  ds_read_b128 v[164:167], v240 offset:576
  v_mfma_f32_16x16x32_bf16 v[52:55], v[140:143], v[96:99], 0
  ds_read_b64 v[196:197], v226 offset:3072
  v_mfma_f32_16x16x32_bf16 v[48:51], v[136:139], v[96:99], 0
  ds_read_b64 v[198:199], v227 offset:3072
  v_mfma_f32_16x16x32_bf16 v[44:47], v[132:135], v[96:99], 0
  ds_read_b128 v[168:171], v240 offset:1088
  v_mfma_f32_16x16x32_bf16 v[40:43], v[128:131], v[96:99], 0
  ds_read_b64 v[200:201], v226 offset:2560
  v_mfma_f32_16x16x32_bf16 v[44:47], v[128:131], v[100:103], v[44:47]
  ds_read_b64 v[202:203], v227 offset:2560
  v_mfma_f32_16x16x32_bf16 v[48:51], v[132:135], v[100:103], v[48:51]
  ds_read_b128 v[172:175], v240 offset:1600
  v_mfma_f32_16x16x32_bf16 v[52:55], v[136:139], v[100:103], v[52:55]
  ds_read_b64 v[204:205], v226 offset:2048
  v_mfma_f32_16x16x32_bf16 v[56:59], v[140:143], v[100:103], v[56:59]
  ds_read_b64 v[206:207], v227 offset:2048
  v_mfma_f32_16x16x32_bf16 v[60:63], v[144:147], v[100:103], v[60:63]
  ds_read_b128 v[176:179], v240 offset:2112
  v_mfma_f32_16x16x32_bf16 v[64:67], v[148:151], v[100:103], v[64:67]
  ds_read_b64 v[208:209], v226 offset:1536
  v_mfma_f32_16x16x32_bf16 v[68:71], v[152:155], v[100:103], v[68:71]
  ds_read_b64 v[210:211], v227 offset:1536
  v_mfma_f32_16x16x32_bf16 v[68:71], v[148:151], v[104:107], v[68:71]
  ds_read_b128 v[180:183], v240 offset:2624
  v_mfma_f32_16x16x32_bf16 v[64:67], v[144:147], v[104:107], v[64:67]
  ds_read_b64 v[212:213], v226 offset:1024
  v_mfma_f32_16x16x32_bf16 v[60:63], v[140:143], v[104:107], v[60:63]
  ds_read_b64 v[214:215], v227 offset:1024
  v_mfma_f32_16x16x32_bf16 v[56:59], v[136:139], v[104:107], v[56:59]
  ds_read_b128 v[184:187], v240 offset:3136
  v_mfma_f32_16x16x32_bf16 v[52:55], v[132:135], v[104:107], v[52:55]
  ds_read_b64 v[216:217], v226 offset:512
  v_mfma_f32_16x16x32_bf16 v[48:51], v[128:131], v[104:107], v[48:51]
  ds_read_b64 v[218:219], v227 offset:512
  v_mfma_f32_16x16x32_bf16 v[52:55], v[128:131], v[108:111], v[52:55]
  ds_read_b128 v[188:191], v240 offset:3648
  v_mfma_f32_16x16x32_bf16 v[56:59], v[132:135], v[108:111], v[56:59]
  ds_read_b64 v[220:221], v226 offset:0
  v_mfma_f32_16x16x32_bf16 v[60:63], v[136:139], v[108:111], v[60:63]
  ds_read_b64 v[222:223], v227 offset:0
  v_mfma_f32_16x16x32_bf16 v[64:67], v[140:143], v[108:111], v[64:67]
  v_mfma_f32_16x16x32_bf16 v[68:71], v[144:147], v[108:111], v[68:71]
  v_mfma_f32_16x16x32_bf16 v[68:71], v[140:143], v[112:115], v[68:71]
  v_mfma_f32_16x16x32_bf16 v[64:67], v[136:139], v[112:115], v[64:67]
  v_mfma_f32_16x16x32_bf16 v[60:63], v[132:135], v[112:115], v[60:63]
  v_mfma_f32_16x16x32_bf16 v[56:59], v[128:131], v[112:115], v[56:59]
  v_mfma_f32_16x16x32_bf16 v[60:63], v[128:131], v[116:119], v[60:63]
  v_mfma_f32_16x16x32_bf16 v[64:67], v[132:135], v[116:119], v[64:67]
  v_mfma_f32_16x16x32_bf16 v[68:71], v[136:139], v[116:119], v[68:71]
  v_mfma_f32_16x16x32_bf16 v[68:71], v[132:135], v[120:123], v[68:71]
  v_mfma_f32_16x16x32_bf16 v[64:67], v[128:131], v[120:123], v[64:67]
  v_mfma_f32_16x16x32_bf16 v[68:71], v[128:131], v[124:127], v[68:71]
  s_waitcnt lgkmcnt(0)
  s_add_u32 m0, s63, 77824
  s_add_u32 s60, s62, 589824
  buffer_load_dwordx4 v241, s[16:19], s60 offen lds
  s_add_u32 m0, s63, 81920
  s_add_u32 s60, s62, 655360
  buffer_load_dwordx4 v241, s[16:19], s60 offen lds
  s_add_u32 m0, s63, 86016
  s_add_u32 s60, s62, 720896
  buffer_load_dwordx4 v241, s[16:19], s60 offen lds
  s_add_u32 m0, s63, 90112
  s_add_u32 s60, s62, 786432
  buffer_load_dwordx4 v241, s[16:19], s60 offen lds
  s_add_u32 m0, s63, 94208
  s_add_u32 s60, s62, 851968
  buffer_load_dwordx4 v241, s[16:19], s60 offen lds
  s_add_u32 m0, s63, 98304
  s_add_u32 s60, s62, 917504
  buffer_load_dwordx4 v241, s[16:19], s60 offen lds
  s_add_u32 m0, s63, 102400
  s_add_u32 s60, s62, 983040
  buffer_load_dwordx4 v241, s[16:19], s60 offen lds
  v_mfma_f32_16x16x32_bf16 v[68:71], v[220:223], v[160:163], v[68:71]
  ds_read_b128 v[96:99], v240 offset:128
  v_mfma_f32_16x16x32_bf16 v[64:67], v[216:219], v[160:163], v[64:67]
  ds_read_b64 v[128:129], v228 offset:3584
  v_mfma_f32_16x16x32_bf16 v[60:63], v[212:215], v[160:163], v[60:63]
  ds_read_b64 v[130:131], v229 offset:3584
  v_mfma_f32_16x16x32_bf16 v[56:59], v[208:211], v[160:163], v[56:59]
  ds_read_b128 v[100:103], v240 offset:640
  v_mfma_f32_16x16x32_bf16 v[52:55], v[204:207], v[160:163], v[52:55]
  ds_read_b64 v[132:133], v228 offset:3072
  v_mfma_f32_16x16x32_bf16 v[48:51], v[200:203], v[160:163], v[48:51]
  ds_read_b64 v[134:135], v229 offset:3072
  v_mfma_f32_16x16x32_bf16 v[44:47], v[196:199], v[160:163], v[44:47]
  ds_read_b128 v[104:107], v240 offset:1152
  v_mfma_f32_16x16x32_bf16 v[40:43], v[192:195], v[160:163], v[40:43]
  ds_read_b64 v[136:137], v228 offset:2560
  v_mfma_f32_16x16x32_bf16 v[44:47], v[192:195], v[164:167], v[44:47]
  ds_read_b64 v[138:139], v229 offset:2560
  v_mfma_f32_16x16x32_bf16 v[48:51], v[196:199], v[164:167], v[48:51]
  ds_read_b128 v[108:111], v240 offset:1664
  v_mfma_f32_16x16x32_bf16 v[52:55], v[200:203], v[164:167], v[52:55]
  ds_read_b64 v[140:141], v228 offset:2048
  v_mfma_f32_16x16x32_bf16 v[56:59], v[204:207], v[164:167], v[56:59]
  ds_read_b64 v[142:143], v229 offset:2048
  v_mfma_f32_16x16x32_bf16 v[60:63], v[208:211], v[164:167], v[60:63]
  ds_read_b128 v[112:115], v240 offset:2176
  v_mfma_f32_16x16x32_bf16 v[64:67], v[212:215], v[164:167], v[64:67]
  ds_read_b64 v[144:145], v228 offset:1536
  v_mfma_f32_16x16x32_bf16 v[68:71], v[216:219], v[164:167], v[68:71]
  ds_read_b64 v[146:147], v229 offset:1536
  v_mfma_f32_16x16x32_bf16 v[68:71], v[212:215], v[168:171], v[68:71]
  ds_read_b128 v[116:119], v240 offset:2688
  v_mfma_f32_16x16x32_bf16 v[64:67], v[208:211], v[168:171], v[64:67]
  ds_read_b64 v[148:149], v228 offset:1024
  v_mfma_f32_16x16x32_bf16 v[60:63], v[204:207], v[168:171], v[60:63]
  ds_read_b64 v[150:151], v229 offset:1024
  v_mfma_f32_16x16x32_bf16 v[56:59], v[200:203], v[168:171], v[56:59]
  ds_read_b128 v[120:123], v240 offset:3200
  v_mfma_f32_16x16x32_bf16 v[52:55], v[196:199], v[168:171], v[52:55]
  ds_read_b64 v[152:153], v228 offset:512
  v_mfma_f32_16x16x32_bf16 v[48:51], v[192:195], v[168:171], v[48:51]
  ds_read_b64 v[154:155], v229 offset:512
  v_mfma_f32_16x16x32_bf16 v[52:55], v[192:195], v[172:175], v[52:55]
  ds_read_b128 v[124:127], v240 offset:3712
  v_mfma_f32_16x16x32_bf16 v[56:59], v[196:199], v[172:175], v[56:59]
  ds_read_b64 v[156:157], v228 offset:0
  v_mfma_f32_16x16x32_bf16 v[60:63], v[200:203], v[172:175], v[60:63]
  ds_read_b64 v[158:159], v229 offset:0
  v_mfma_f32_16x16x32_bf16 v[64:67], v[204:207], v[172:175], v[64:67]
  v_mfma_f32_16x16x32_bf16 v[68:71], v[208:211], v[172:175], v[68:71]
  v_mfma_f32_16x16x32_bf16 v[68:71], v[204:207], v[176:179], v[68:71]
  v_mfma_f32_16x16x32_bf16 v[64:67], v[200:203], v[176:179], v[64:67]
  v_mfma_f32_16x16x32_bf16 v[60:63], v[196:199], v[176:179], v[60:63]
  v_mfma_f32_16x16x32_bf16 v[56:59], v[192:195], v[176:179], v[56:59]
  v_mfma_f32_16x16x32_bf16 v[60:63], v[192:195], v[180:183], v[60:63]
  v_mfma_f32_16x16x32_bf16 v[64:67], v[196:199], v[180:183], v[64:67]
  v_mfma_f32_16x16x32_bf16 v[68:71], v[200:203], v[180:183], v[68:71]
  v_mfma_f32_16x16x32_bf16 v[68:71], v[196:199], v[184:187], v[68:71]
  v_mfma_f32_16x16x32_bf16 v[64:67], v[192:195], v[184:187], v[64:67]
  v_mfma_f32_16x16x32_bf16 v[68:71], v[192:195], v[188:191], v[68:71]
  s_waitcnt lgkmcnt(0)
  v_mfma_f32_16x16x32_bf16 v[68:71], v[156:159], v[96:99], v[68:71]
  ds_read_b128 v[160:163], v240 offset:192
  v_mfma_f32_16x16x32_bf16 v[64:67], v[152:155], v[96:99], v[64:67]
  ds_read_b64 v[192:193], v230 offset:3584
  v_mfma_f32_16x16x32_bf16 v[60:63], v[148:151], v[96:99], v[60:63]
  ds_read_b64 v[194:195], v231 offset:3584
  v_mfma_f32_16x16x32_bf16 v[56:59], v[144:147], v[96:99], v[56:59]
  ds_read_b128 v[164:167], v240 offset:704
  v_mfma_f32_16x16x32_bf16 v[52:55], v[140:143], v[96:99], v[52:55]
  ds_read_b64 v[196:197], v230 offset:3072
  v_mfma_f32_16x16x32_bf16 v[48:51], v[136:139], v[96:99], v[48:51]
  ds_read_b64 v[198:199], v231 offset:3072
  v_mfma_f32_16x16x32_bf16 v[44:47], v[132:135], v[96:99], v[44:47]
  ds_read_b128 v[168:171], v240 offset:1216
  v_mfma_f32_16x16x32_bf16 v[40:43], v[128:131], v[96:99], v[40:43]
  ds_read_b64 v[200:201], v230 offset:2560
  v_mfma_f32_16x16x32_bf16 v[44:47], v[128:131], v[100:103], v[44:47]
  ds_read_b64 v[202:203], v231 offset:2560
  v_mfma_f32_16x16x32_bf16 v[48:51], v[132:135], v[100:103], v[48:51]
  ds_read_b128 v[172:175], v240 offset:1728
  v_mfma_f32_16x16x32_bf16 v[52:55], v[136:139], v[100:103], v[52:55]
  ds_read_b64 v[204:205], v230 offset:2048
  v_mfma_f32_16x16x32_bf16 v[56:59], v[140:143], v[100:103], v[56:59]
  ds_read_b64 v[206:207], v231 offset:2048
  v_mfma_f32_16x16x32_bf16 v[60:63], v[144:147], v[100:103], v[60:63]
  ds_read_b128 v[176:179], v240 offset:2240
  v_mfma_f32_16x16x32_bf16 v[64:67], v[148:151], v[100:103], v[64:67]
  ds_read_b64 v[208:209], v230 offset:1536
  v_mfma_f32_16x16x32_bf16 v[68:71], v[152:155], v[100:103], v[68:71]
  ds_read_b64 v[210:211], v231 offset:1536
  v_mfma_f32_16x16x32_bf16 v[68:71], v[148:151], v[104:107], v[68:71]
  ds_read_b128 v[180:183], v240 offset:2752
  v_mfma_f32_16x16x32_bf16 v[64:67], v[144:147], v[104:107], v[64:67]
  ds_read_b64 v[212:213], v230 offset:1024
  v_mfma_f32_16x16x32_bf16 v[60:63], v[140:143], v[104:107], v[60:63]
  ds_read_b64 v[214:215], v231 offset:1024
  v_mfma_f32_16x16x32_bf16 v[56:59], v[136:139], v[104:107], v[56:59]
  ds_read_b128 v[184:187], v240 offset:3264
  v_mfma_f32_16x16x32_bf16 v[52:55], v[132:135], v[104:107], v[52:55]
  ds_read_b64 v[216:217], v230 offset:512
  v_mfma_f32_16x16x32_bf16 v[48:51], v[128:131], v[104:107], v[48:51]
  ds_read_b64 v[218:219], v231 offset:512
  v_mfma_f32_16x16x32_bf16 v[52:55], v[128:131], v[108:111], v[52:55]
  ds_read_b128 v[188:191], v240 offset:3776
  v_mfma_f32_16x16x32_bf16 v[56:59], v[132:135], v[108:111], v[56:59]
  ds_read_b64 v[220:221], v230 offset:0
  v_mfma_f32_16x16x32_bf16 v[60:63], v[136:139], v[108:111], v[60:63]
  ds_read_b64 v[222:223], v231 offset:0
  v_mfma_f32_16x16x32_bf16 v[64:67], v[140:143], v[108:111], v[64:67]
  v_mfma_f32_16x16x32_bf16 v[68:71], v[144:147], v[108:111], v[68:71]
  v_mfma_f32_16x16x32_bf16 v[68:71], v[140:143], v[112:115], v[68:71]
  v_mfma_f32_16x16x32_bf16 v[64:67], v[136:139], v[112:115], v[64:67]
  v_mfma_f32_16x16x32_bf16 v[60:63], v[132:135], v[112:115], v[60:63]
  v_mfma_f32_16x16x32_bf16 v[56:59], v[128:131], v[112:115], v[56:59]
  v_mfma_f32_16x16x32_bf16 v[60:63], v[128:131], v[116:119], v[60:63]
  v_mfma_f32_16x16x32_bf16 v[64:67], v[132:135], v[116:119], v[64:67]
  v_mfma_f32_16x16x32_bf16 v[68:71], v[136:139], v[116:119], v[68:71]
  v_mfma_f32_16x16x32_bf16 v[68:71], v[132:135], v[120:123], v[68:71]
  v_mfma_f32_16x16x32_bf16 v[64:67], v[128:131], v[120:123], v[64:67]
  v_mfma_f32_16x16x32_bf16 v[68:71], v[128:131], v[124:127], v[68:71]
  s_waitcnt lgkmcnt(0)
  v_mfma_f32_16x16x32_bf16 v[68:71], v[220:223], v[160:163], v[68:71]
  ds_read_b128 v[96:99], v240 offset:256
  v_mfma_f32_16x16x32_bf16 v[64:67], v[216:219], v[160:163], v[64:67]
  ds_read_b64 v[128:129], v232 offset:3584
  v_mfma_f32_16x16x32_bf16 v[60:63], v[212:215], v[160:163], v[60:63]
  ds_read_b64 v[130:131], v233 offset:3584
  v_mfma_f32_16x16x32_bf16 v[56:59], v[208:211], v[160:163], v[56:59]
  ds_read_b128 v[100:103], v240 offset:768
  v_mfma_f32_16x16x32_bf16 v[52:55], v[204:207], v[160:163], v[52:55]
  ds_read_b64 v[132:133], v232 offset:3072
  v_mfma_f32_16x16x32_bf16 v[48:51], v[200:203], v[160:163], v[48:51]
  ds_read_b64 v[134:135], v233 offset:3072
  v_mfma_f32_16x16x32_bf16 v[44:47], v[196:199], v[160:163], v[44:47]
  ds_read_b128 v[104:107], v240 offset:1280
  v_mfma_f32_16x16x32_bf16 v[40:43], v[192:195], v[160:163], v[40:43]
  ds_read_b64 v[136:137], v232 offset:2560
  v_mfma_f32_16x16x32_bf16 v[44:47], v[192:195], v[164:167], v[44:47]
  ds_read_b64 v[138:139], v233 offset:2560
  v_mfma_f32_16x16x32_bf16 v[48:51], v[196:199], v[164:167], v[48:51]
  ds_read_b128 v[108:111], v240 offset:1792
  v_mfma_f32_16x16x32_bf16 v[52:55], v[200:203], v[164:167], v[52:55]
  ds_read_b64 v[140:141], v232 offset:2048
  v_mfma_f32_16x16x32_bf16 v[56:59], v[204:207], v[164:167], v[56:59]
  ds_read_b64 v[142:143], v233 offset:2048
  v_mfma_f32_16x16x32_bf16 v[60:63], v[208:211], v[164:167], v[60:63]
  ds_read_b128 v[112:115], v240 offset:2304
  v_mfma_f32_16x16x32_bf16 v[64:67], v[212:215], v[164:167], v[64:67]
  ds_read_b64 v[144:145], v232 offset:1536
  v_mfma_f32_16x16x32_bf16 v[68:71], v[216:219], v[164:167], v[68:71]
  ds_read_b64 v[146:147], v233 offset:1536
  v_mfma_f32_16x16x32_bf16 v[68:71], v[212:215], v[168:171], v[68:71]
  ds_read_b128 v[116:119], v240 offset:2816
  v_mfma_f32_16x16x32_bf16 v[64:67], v[208:211], v[168:171], v[64:67]
  ds_read_b64 v[148:149], v232 offset:1024
  v_mfma_f32_16x16x32_bf16 v[60:63], v[204:207], v[168:171], v[60:63]
  ds_read_b64 v[150:151], v233 offset:1024
  v_mfma_f32_16x16x32_bf16 v[56:59], v[200:203], v[168:171], v[56:59]
  ds_read_b128 v[120:123], v240 offset:3328
  v_mfma_f32_16x16x32_bf16 v[52:55], v[196:199], v[168:171], v[52:55]
  ds_read_b64 v[152:153], v232 offset:512
  v_mfma_f32_16x16x32_bf16 v[48:51], v[192:195], v[168:171], v[48:51]
  ds_read_b64 v[154:155], v233 offset:512
  v_mfma_f32_16x16x32_bf16 v[52:55], v[192:195], v[172:175], v[52:55]
  ds_read_b128 v[124:127], v240 offset:3840
  v_mfma_f32_16x16x32_bf16 v[56:59], v[196:199], v[172:175], v[56:59]
  ds_read_b64 v[156:157], v232 offset:0
  v_mfma_f32_16x16x32_bf16 v[60:63], v[200:203], v[172:175], v[60:63]
  ds_read_b64 v[158:159], v233 offset:0
  v_mfma_f32_16x16x32_bf16 v[64:67], v[204:207], v[172:175], v[64:67]
  v_mfma_f32_16x16x32_bf16 v[68:71], v[208:211], v[172:175], v[68:71]
  v_mfma_f32_16x16x32_bf16 v[68:71], v[204:207], v[176:179], v[68:71]
  v_mfma_f32_16x16x32_bf16 v[64:67], v[200:203], v[176:179], v[64:67]
  v_mfma_f32_16x16x32_bf16 v[60:63], v[196:199], v[176:179], v[60:63]
  v_mfma_f32_16x16x32_bf16 v[56:59], v[192:195], v[176:179], v[56:59]
  v_mfma_f32_16x16x32_bf16 v[60:63], v[192:195], v[180:183], v[60:63]
  v_mfma_f32_16x16x32_bf16 v[64:67], v[196:199], v[180:183], v[64:67]
  v_mfma_f32_16x16x32_bf16 v[68:71], v[200:203], v[180:183], v[68:71]
  v_mfma_f32_16x16x32_bf16 v[68:71], v[196:199], v[184:187], v[68:71]
  v_mfma_f32_16x16x32_bf16 v[64:67], v[192:195], v[184:187], v[64:67]
  v_mfma_f32_16x16x32_bf16 v[68:71], v[192:195], v[188:191], v[68:71]
  s_waitcnt lgkmcnt(0)
  v_mfma_f32_16x16x32_bf16 v[68:71], v[156:159], v[96:99], v[68:71]
  ds_read_b128 v[160:163], v240 offset:320
  v_mfma_f32_16x16x32_bf16 v[64:67], v[152:155], v[96:99], v[64:67]
  ds_read_b64 v[192:193], v234 offset:3584
  v_mfma_f32_16x16x32_bf16 v[60:63], v[148:151], v[96:99], v[60:63]
  ds_read_b64 v[194:195], v235 offset:3584
  v_mfma_f32_16x16x32_bf16 v[56:59], v[144:147], v[96:99], v[56:59]
  ds_read_b128 v[164:167], v240 offset:832
  v_mfma_f32_16x16x32_bf16 v[52:55], v[140:143], v[96:99], v[52:55]
  ds_read_b64 v[196:197], v234 offset:3072
  v_mfma_f32_16x16x32_bf16 v[48:51], v[136:139], v[96:99], v[48:51]
  ds_read_b64 v[198:199], v235 offset:3072
  v_mfma_f32_16x16x32_bf16 v[44:47], v[132:135], v[96:99], v[44:47]
  ds_read_b128 v[168:171], v240 offset:1344
  v_mfma_f32_16x16x32_bf16 v[40:43], v[128:131], v[96:99], v[40:43]
  ds_read_b64 v[200:201], v234 offset:2560
  v_mfma_f32_16x16x32_bf16 v[44:47], v[128:131], v[100:103], v[44:47]
  ds_read_b64 v[202:203], v235 offset:2560
  v_mfma_f32_16x16x32_bf16 v[48:51], v[132:135], v[100:103], v[48:51]
  ds_read_b128 v[172:175], v240 offset:1856
  v_mfma_f32_16x16x32_bf16 v[52:55], v[136:139], v[100:103], v[52:55]
  ds_read_b64 v[204:205], v234 offset:2048
  v_mfma_f32_16x16x32_bf16 v[56:59], v[140:143], v[100:103], v[56:59]
  ds_read_b64 v[206:207], v235 offset:2048
  v_mfma_f32_16x16x32_bf16 v[60:63], v[144:147], v[100:103], v[60:63]
  ds_read_b128 v[176:179], v240 offset:2368
  v_mfma_f32_16x16x32_bf16 v[64:67], v[148:151], v[100:103], v[64:67]
  ds_read_b64 v[208:209], v234 offset:1536
  v_mfma_f32_16x16x32_bf16 v[68:71], v[152:155], v[100:103], v[68:71]
  ds_read_b64 v[210:211], v235 offset:1536
  v_mfma_f32_16x16x32_bf16 v[68:71], v[148:151], v[104:107], v[68:71]
  ds_read_b128 v[180:183], v240 offset:2880
  v_mfma_f32_16x16x32_bf16 v[64:67], v[144:147], v[104:107], v[64:67]
  ds_read_b64 v[212:213], v234 offset:1024
  v_mfma_f32_16x16x32_bf16 v[60:63], v[140:143], v[104:107], v[60:63]
  ds_read_b64 v[214:215], v235 offset:1024
  v_mfma_f32_16x16x32_bf16 v[56:59], v[136:139], v[104:107], v[56:59]
  ds_read_b128 v[184:187], v240 offset:3392
  v_mfma_f32_16x16x32_bf16 v[52:55], v[132:135], v[104:107], v[52:55]
  ds_read_b64 v[216:217], v234 offset:512
  v_mfma_f32_16x16x32_bf16 v[48:51], v[128:131], v[104:107], v[48:51]
  ds_read_b64 v[218:219], v235 offset:512
  v_mfma_f32_16x16x32_bf16 v[52:55], v[128:131], v[108:111], v[52:55]
  ds_read_b128 v[188:191], v240 offset:3904
  v_mfma_f32_16x16x32_bf16 v[56:59], v[132:135], v[108:111], v[56:59]
  ds_read_b64 v[220:221], v234 offset:0
  v_mfma_f32_16x16x32_bf16 v[60:63], v[136:139], v[108:111], v[60:63]
  ds_read_b64 v[222:223], v235 offset:0
  v_mfma_f32_16x16x32_bf16 v[64:67], v[140:143], v[108:111], v[64:67]
  v_mfma_f32_16x16x32_bf16 v[68:71], v[144:147], v[108:111], v[68:71]
  v_mfma_f32_16x16x32_bf16 v[68:71], v[140:143], v[112:115], v[68:71]
  v_mfma_f32_16x16x32_bf16 v[64:67], v[136:139], v[112:115], v[64:67]
  v_mfma_f32_16x16x32_bf16 v[60:63], v[132:135], v[112:115], v[60:63]
  v_mfma_f32_16x16x32_bf16 v[56:59], v[128:131], v[112:115], v[56:59]
  v_mfma_f32_16x16x32_bf16 v[60:63], v[128:131], v[116:119], v[60:63]
  v_mfma_f32_16x16x32_bf16 v[64:67], v[132:135], v[116:119], v[64:67]
  v_mfma_f32_16x16x32_bf16 v[68:71], v[136:139], v[116:119], v[68:71]
  v_mfma_f32_16x16x32_bf16 v[68:71], v[132:135], v[120:123], v[68:71]
  v_mfma_f32_16x16x32_bf16 v[64:67], v[128:131], v[120:123], v[64:67]
  v_mfma_f32_16x16x32_bf16 v[68:71], v[128:131], v[124:127], v[68:71]
  s_waitcnt lgkmcnt(0)
  s_waitcnt vmcnt(0)
  s_mov_b64 exec, 1
  ds_add_u32 v242, v243 offset:80
  s_mov_b64 exec, -1
  v_mfma_f32_16x16x32_bf16 v[68:71], v[220:223], v[160:163], v[68:71]
  ds_read_b128 v[96:99], v240 offset:384
  v_mfma_f32_16x16x32_bf16 v[64:67], v[216:219], v[160:163], v[64:67]
  ds_read_b64 v[128:129], v236 offset:3584
  v_mfma_f32_16x16x32_bf16 v[60:63], v[212:215], v[160:163], v[60:63]
  ds_read_b64 v[130:131], v237 offset:3584
  v_mfma_f32_16x16x32_bf16 v[56:59], v[208:211], v[160:163], v[56:59]
  ds_read_b128 v[100:103], v240 offset:896
  v_mfma_f32_16x16x32_bf16 v[52:55], v[204:207], v[160:163], v[52:55]
  ds_read_b64 v[132:133], v236 offset:3072
  v_mfma_f32_16x16x32_bf16 v[48:51], v[200:203], v[160:163], v[48:51]
  ds_read_b64 v[134:135], v237 offset:3072
  v_mfma_f32_16x16x32_bf16 v[44:47], v[196:199], v[160:163], v[44:47]
  ds_read_b128 v[104:107], v240 offset:1408
  v_mfma_f32_16x16x32_bf16 v[40:43], v[192:195], v[160:163], v[40:43]
  ds_read_b64 v[136:137], v236 offset:2560
  v_mfma_f32_16x16x32_bf16 v[44:47], v[192:195], v[164:167], v[44:47]
  ds_read_b64 v[138:139], v237 offset:2560
  v_mfma_f32_16x16x32_bf16 v[48:51], v[196:199], v[164:167], v[48:51]
  ds_read_b128 v[108:111], v240 offset:1920
  v_mfma_f32_16x16x32_bf16 v[52:55], v[200:203], v[164:167], v[52:55]
  ds_read_b64 v[140:141], v236 offset:2048
  v_mfma_f32_16x16x32_bf16 v[56:59], v[204:207], v[164:167], v[56:59]
  ds_read_b64 v[142:143], v237 offset:2048
  v_mfma_f32_16x16x32_bf16 v[60:63], v[208:211], v[164:167], v[60:63]
  ds_read_b128 v[112:115], v240 offset:2432
  v_mfma_f32_16x16x32_bf16 v[64:67], v[212:215], v[164:167], v[64:67]
  ds_read_b64 v[144:145], v236 offset:1536
  v_mfma_f32_16x16x32_bf16 v[68:71], v[216:219], v[164:167], v[68:71]
  ds_read_b64 v[146:147], v237 offset:1536
  v_mfma_f32_16x16x32_bf16 v[68:71], v[212:215], v[168:171], v[68:71]
  ds_read_b128 v[116:119], v240 offset:2944
  v_mfma_f32_16x16x32_bf16 v[64:67], v[208:211], v[168:171], v[64:67]
  ds_read_b64 v[148:149], v236 offset:1024
  v_mfma_f32_16x16x32_bf16 v[60:63], v[204:207], v[168:171], v[60:63]
  ds_read_b64 v[150:151], v237 offset:1024
  v_mfma_f32_16x16x32_bf16 v[56:59], v[200:203], v[168:171], v[56:59]
  ds_read_b128 v[120:123], v240 offset:3456
  v_mfma_f32_16x16x32_bf16 v[52:55], v[196:199], v[168:171], v[52:55]
  ds_read_b64 v[152:153], v236 offset:512
  v_mfma_f32_16x16x32_bf16 v[48:51], v[192:195], v[168:171], v[48:51]
  ds_read_b64 v[154:155], v237 offset:512
  v_mfma_f32_16x16x32_bf16 v[52:55], v[192:195], v[172:175], v[52:55]
  ds_read_b128 v[124:127], v240 offset:3968
  v_mfma_f32_16x16x32_bf16 v[56:59], v[196:199], v[172:175], v[56:59]
  ds_read_b64 v[156:157], v236 offset:0
  v_mfma_f32_16x16x32_bf16 v[60:63], v[200:203], v[172:175], v[60:63]
  ds_read_b64 v[158:159], v237 offset:0
  v_mfma_f32_16x16x32_bf16 v[64:67], v[204:207], v[172:175], v[64:67]
  v_mfma_f32_16x16x32_bf16 v[68:71], v[208:211], v[172:175], v[68:71]
  v_mfma_f32_16x16x32_bf16 v[68:71], v[204:207], v[176:179], v[68:71]
  v_mfma_f32_16x16x32_bf16 v[64:67], v[200:203], v[176:179], v[64:67]
  v_mfma_f32_16x16x32_bf16 v[60:63], v[196:199], v[176:179], v[60:63]
  v_mfma_f32_16x16x32_bf16 v[56:59], v[192:195], v[176:179], v[56:59]
  v_mfma_f32_16x16x32_bf16 v[60:63], v[192:195], v[180:183], v[60:63]
  v_mfma_f32_16x16x32_bf16 v[64:67], v[196:199], v[180:183], v[64:67]
  v_mfma_f32_16x16x32_bf16 v[68:71], v[200:203], v[180:183], v[68:71]
  v_mfma_f32_16x16x32_bf16 v[68:71], v[196:199], v[184:187], v[68:71]
  v_mfma_f32_16x16x32_bf16 v[64:67], v[192:195], v[184:187], v[64:67]
  v_mfma_f32_16x16x32_bf16 v[68:71], v[192:195], v[188:191], v[68:71]
  s_waitcnt lgkmcnt(0)
  v_mfma_f32_16x16x32_bf16 v[68:71], v[156:159], v[96:99], v[68:71]
  ds_read_b128 v[160:163], v240 offset:448
  v_mfma_f32_16x16x32_bf16 v[64:67], v[152:155], v[96:99], v[64:67]
  ds_read_b64 v[192:193], v238 offset:3584
  v_mfma_f32_16x16x32_bf16 v[60:63], v[148:151], v[96:99], v[60:63]
  ds_read_b64 v[194:195], v239 offset:3584
  v_mfma_f32_16x16x32_bf16 v[56:59], v[144:147], v[96:99], v[56:59]
  ds_read_b128 v[164:167], v240 offset:960
  v_mfma_f32_16x16x32_bf16 v[52:55], v[140:143], v[96:99], v[52:55]
  ds_read_b64 v[196:197], v238 offset:3072
  v_mfma_f32_16x16x32_bf16 v[48:51], v[136:139], v[96:99], v[48:51]
  ds_read_b64 v[198:199], v239 offset:3072
  v_mfma_f32_16x16x32_bf16 v[44:47], v[132:135], v[96:99], v[44:47]
  ds_read_b128 v[168:171], v240 offset:1472
  v_mfma_f32_16x16x32_bf16 v[40:43], v[128:131], v[96:99], v[40:43]
  ds_read_b64 v[200:201], v238 offset:2560
  v_mfma_f32_16x16x32_bf16 v[44:47], v[128:131], v[100:103], v[44:47]
  ds_read_b64 v[202:203], v239 offset:2560
  v_mfma_f32_16x16x32_bf16 v[48:51], v[132:135], v[100:103], v[48:51]
  ds_read_b128 v[172:175], v240 offset:1984
  v_mfma_f32_16x16x32_bf16 v[52:55], v[136:139], v[100:103], v[52:55]
  ds_read_b64 v[204:205], v238 offset:2048
  v_mfma_f32_16x16x32_bf16 v[56:59], v[140:143], v[100:103], v[56:59]
  ds_read_b64 v[206:207], v239 offset:2048
  v_mfma_f32_16x16x32_bf16 v[60:63], v[144:147], v[100:103], v[60:63]
  ds_read_b128 v[176:179], v240 offset:2496
  v_mfma_f32_16x16x32_bf16 v[64:67], v[148:151], v[100:103], v[64:67]
  ds_read_b64 v[208:209], v238 offset:1536
  v_mfma_f32_16x16x32_bf16 v[68:71], v[152:155], v[100:103], v[68:71]
  ds_read_b64 v[210:211], v239 offset:1536
  v_mfma_f32_16x16x32_bf16 v[68:71], v[148:151], v[104:107], v[68:71]
  ds_read_b128 v[180:183], v240 offset:3008
  v_mfma_f32_16x16x32_bf16 v[64:67], v[144:147], v[104:107], v[64:67]
  ds_read_b64 v[212:213], v238 offset:1024
  v_mfma_f32_16x16x32_bf16 v[60:63], v[140:143], v[104:107], v[60:63]
  ds_read_b64 v[214:215], v239 offset:1024
  v_mfma_f32_16x16x32_bf16 v[56:59], v[136:139], v[104:107], v[56:59]
  ds_read_b128 v[184:187], v240 offset:3520
  v_mfma_f32_16x16x32_bf16 v[52:55], v[132:135], v[104:107], v[52:55]
  ds_read_b64 v[216:217], v238 offset:512
  v_mfma_f32_16x16x32_bf16 v[48:51], v[128:131], v[104:107], v[48:51]
  ds_read_b64 v[218:219], v239 offset:512
  v_mfma_f32_16x16x32_bf16 v[52:55], v[128:131], v[108:111], v[52:55]
  ds_read_b128 v[188:191], v240 offset:4032
  v_mfma_f32_16x16x32_bf16 v[56:59], v[132:135], v[108:111], v[56:59]
  ds_read_b64 v[220:221], v238 offset:0
  v_mfma_f32_16x16x32_bf16 v[60:63], v[136:139], v[108:111], v[60:63]
  ds_read_b64 v[222:223], v239 offset:0
  v_mfma_f32_16x16x32_bf16 v[64:67], v[140:143], v[108:111], v[64:67]
  v_mfma_f32_16x16x32_bf16 v[68:71], v[144:147], v[108:111], v[68:71]
  v_mfma_f32_16x16x32_bf16 v[68:71], v[140:143], v[112:115], v[68:71]
  v_mfma_f32_16x16x32_bf16 v[64:67], v[136:139], v[112:115], v[64:67]
  v_mfma_f32_16x16x32_bf16 v[60:63], v[132:135], v[112:115], v[60:63]
  v_mfma_f32_16x16x32_bf16 v[56:59], v[128:131], v[112:115], v[56:59]
  v_mfma_f32_16x16x32_bf16 v[60:63], v[128:131], v[116:119], v[60:63]
  v_mfma_f32_16x16x32_bf16 v[64:67], v[132:135], v[116:119], v[64:67]
  v_mfma_f32_16x16x32_bf16 v[68:71], v[136:139], v[116:119], v[68:71]
  v_mfma_f32_16x16x32_bf16 v[68:71], v[132:135], v[120:123], v[68:71]
  v_mfma_f32_16x16x32_bf16 v[64:67], v[128:131], v[120:123], v[64:67]
  v_mfma_f32_16x16x32_bf16 v[68:71], v[128:131], v[124:127], v[68:71]
  s_waitcnt lgkmcnt(0)
  v_mfma_f32_16x16x32_bf16 v[68:71], v[220:223], v[160:163], v[68:71]
  v_mfma_f32_16x16x32_bf16 v[64:67], v[216:219], v[160:163], v[64:67]
  v_mfma_f32_16x16x32_bf16 v[60:63], v[212:215], v[160:163], v[60:63]
  v_mfma_f32_16x16x32_bf16 v[56:59], v[208:211], v[160:163], v[56:59]
  v_mfma_f32_16x16x32_bf16 v[52:55], v[204:207], v[160:163], v[52:55]
  v_mfma_f32_16x16x32_bf16 v[48:51], v[200:203], v[160:163], v[48:51]
  v_mfma_f32_16x16x32_bf16 v[44:47], v[196:199], v[160:163], v[44:47]
  v_mfma_f32_16x16x32_bf16 v[40:43], v[192:195], v[160:163], v[40:43]
  v_mfma_f32_16x16x32_bf16 v[44:47], v[192:195], v[164:167], v[44:47]
  v_mfma_f32_16x16x32_bf16 v[48:51], v[196:199], v[164:167], v[48:51]
  v_mfma_f32_16x16x32_bf16 v[52:55], v[200:203], v[164:167], v[52:55]
  v_mfma_f32_16x16x32_bf16 v[56:59], v[204:207], v[164:167], v[56:59]
  v_mfma_f32_16x16x32_bf16 v[60:63], v[208:211], v[164:167], v[60:63]
  v_mfma_f32_16x16x32_bf16 v[64:67], v[212:215], v[164:167], v[64:67]
  v_mfma_f32_16x16x32_bf16 v[68:71], v[216:219], v[164:167], v[68:71]
  v_mfma_f32_16x16x32_bf16 v[68:71], v[212:215], v[168:171], v[68:71]
  v_mfma_f32_16x16x32_bf16 v[64:67], v[208:211], v[168:171], v[64:67]
  v_mfma_f32_16x16x32_bf16 v[60:63], v[204:207], v[168:171], v[60:63]
  v_mfma_f32_16x16x32_bf16 v[56:59], v[200:203], v[168:171], v[56:59]
  v_mfma_f32_16x16x32_bf16 v[52:55], v[196:199], v[168:171], v[52:55]
  v_mfma_f32_16x16x32_bf16 v[48:51], v[192:195], v[168:171], v[48:51]
  v_mfma_f32_16x16x32_bf16 v[52:55], v[192:195], v[172:175], v[52:55]
  v_mfma_f32_16x16x32_bf16 v[56:59], v[196:199], v[172:175], v[56:59]
  v_mfma_f32_16x16x32_bf16 v[60:63], v[200:203], v[172:175], v[60:63]
  v_mfma_f32_16x16x32_bf16 v[64:67], v[204:207], v[172:175], v[64:67]
  v_mfma_f32_16x16x32_bf16 v[68:71], v[208:211], v[172:175], v[68:71]
  v_mfma_f32_16x16x32_bf16 v[68:71], v[204:207], v[176:179], v[68:71]
  v_mfma_f32_16x16x32_bf16 v[64:67], v[200:203], v[176:179], v[64:67]
  v_mfma_f32_16x16x32_bf16 v[60:63], v[196:199], v[176:179], v[60:63]
  v_mfma_f32_16x16x32_bf16 v[56:59], v[192:195], v[176:179], v[56:59]
  v_mfma_f32_16x16x32_bf16 v[60:63], v[192:195], v[180:183], v[60:63]
  v_mfma_f32_16x16x32_bf16 v[64:67], v[196:199], v[180:183], v[64:67]
  v_mfma_f32_16x16x32_bf16 v[68:71], v[200:203], v[180:183], v[68:71]
  v_mfma_f32_16x16x32_bf16 v[68:71], v[196:199], v[184:187], v[68:71]
  v_mfma_f32_16x16x32_bf16 v[64:67], v[192:195], v[184:187], v[64:67]
  v_mfma_f32_16x16x32_bf16 v[68:71], v[192:195], v[188:191], v[68:71]
  s_cmp_eq_u32 s32, 0
  s_cselect_b32 s97, 157696, s97
  v_and_b32 v2, 1, v0
  v_bfe_u32 v3, v0, 1, 3
  v_lshl_add_u32 v2, v3, 2, v2
  v_lshrrev_b32 v3, 4, v0
  v_lshl_add_u32 v2, v3, 5, v2
  v_lshl_add_u32 v2, v2, 2, s97
  v_cvt_pk_bf16_f32 v96, v40, v41
  v_cvt_pk_bf16_f32 v97, v42, v43
  ds_write2_b32 v2, v96, v97 offset0:0 offset1:2
  v_cvt_pk_bf16_f32 v98, v44, v45
  v_cvt_pk_bf16_f32 v99, v46, v47
  ds_write2_b32 v2, v98, v99 offset0:128 offset1:130
  v_cvt_pk_bf16_f32 v100, v48, v49
  v_cvt_pk_bf16_f32 v101, v50, v51
  v_add_u32 v2, 1024, v2
  ds_write2_b32 v2, v100, v101 offset0:0 offset1:2
  v_cvt_pk_bf16_f32 v102, v52, v53
  v_cvt_pk_bf16_f32 v103, v54, v55
  ds_write2_b32 v2, v102, v103 offset0:128 offset1:130
  v_cvt_pk_bf16_f32 v104, v56, v57
  v_cvt_pk_bf16_f32 v105, v58, v59
  v_add_u32 v2, 1024, v2
  ds_write2_b32 v2, v104, v105 offset0:0 offset1:2
  v_cvt_pk_bf16_f32 v106, v60, v61
  v_cvt_pk_bf16_f32 v107, v62, v63
  ds_write2_b32 v2, v106, v107 offset0:128 offset1:130
  v_cvt_pk_bf16_f32 v108, v64, v65
  v_cvt_pk_bf16_f32 v109, v66, v67
  v_add_u32 v2, 1024, v2
  ds_write2_b32 v2, v108, v109 offset0:0 offset1:2
  v_cvt_pk_bf16_f32 v110, v68, v69
  v_cvt_pk_bf16_f32 v111, v70, v71
  ds_write2_b32 v2, v110, v111 offset0:128 offset1:130
  v_mov_b32 v210, 161792
  v_mov_b32 v211, 1
  s_mov_b64 exec, 1
  ds_add_u32 v210, v211 offset:60
  s_mov_b64 exec, -1
  s_lshl_b32 s3, s32, 10
  v_lshl_add_u32 v2, v0, 2, s3
  v_add_u32 v3, 122880, v2
  v_lshlrev_b32 v2, 2, v2
  s_lshl_b32 s61, s29, 14
  s_add_u32 s61, s61, 8388608
  s_mov_b32 s58, 0
L_spin_13:
  ds_read_b32 v212, v210 offset:60
  s_waitcnt lgkmcnt(0)
  v_readfirstlane_b32 s59, v212
  s_add_u32 s58, s58, 1
  s_cmp_eq_u32 s59, 4
  s_cbranch_scc1 L_spun_14
  s_cmp_lt_u32 s58, 4194304
  s_cbranch_scc1 L_spin_13
L_spun_14:
  ds_read_b32 v96, v3 offset:34816
  ds_read_b32 v97, v3 offset:8704
  ds_read_b32 v98, v3 offset:17408
  ds_read_b32 v99, v3 offset:26112
  ds_read_b32 v100, v3 offset:35072
  ds_read_b32 v101, v3 offset:8960
  ds_read_b32 v102, v3 offset:17664
  ds_read_b32 v103, v3 offset:26368
  ds_read_b32 v104, v3 offset:35328
  ds_read_b32 v105, v3 offset:9216
  ds_read_b32 v106, v3 offset:17920
  ds_read_b32 v107, v3 offset:26624
  ds_read_b32 v108, v3 offset:35584
  ds_read_b32 v109, v3 offset:9472
  ds_read_b32 v110, v3 offset:18176
  ds_read_b32 v111, v3 offset:26880
  s_waitcnt lgkmcnt(0)
  v_perm_b32 v112, v97, v96, s94
  v_perm_b32 v113, v99, v98, s94
  v_perm_b32 v114, v97, v96, s95
  v_perm_b32 v115, v99, v98, s95
  buffer_store_dwordx4 v[112:115], v2, s[12:15], s61 offen offset:0 sc1
  v_perm_b32 v116, v101, v100, s94
  v_perm_b32 v117, v103, v102, s94
  v_perm_b32 v118, v101, v100, s95
  v_perm_b32 v119, v103, v102, s95
  buffer_store_dwordx4 v[116:119], v2, s[12:15], s61 offen offset:1024 sc1
  v_perm_b32 v120, v105, v104, s94
  v_perm_b32 v121, v107, v106, s94
  v_perm_b32 v122, v105, v104, s95
  v_perm_b32 v123, v107, v106, s95
  buffer_store_dwordx4 v[120:123], v2, s[12:15], s61 offen offset:2048 sc1
  v_perm_b32 v124, v109, v108, s94
  v_perm_b32 v125, v111, v110, s94
  v_perm_b32 v126, v109, v108, s95
  v_perm_b32 v127, v111, v110, s95
  buffer_store_dwordx4 v[124:127], v2, s[12:15], s61 offen offset:3072 sc1
  s_waitcnt vmcnt(0)
  s_lshr_b32 s38, s29, 4
  s_and_b32 s39, s29, 15
  s_mov_b64 exec, 1
  ds_add_rtn_u32 v213, v210, v211 offset:64
  ds_read_b64 v[214:215], v210 offset:0
  s_lshl_b32 s94, s38, 8
  s_add_u32 s94, s94, 13639680
  s_lshl_b32 s95, s39, 3
  s_add_u32 s95, s95, s94
  v_mov_b32 v212, 0
  s_waitcnt lgkmcnt(0)
  v_readfirstlane_b32 s3, v213
  s_nop 0
  s_cmp_lg_u32 s3, 3
  s_cbranch_scc1 L_nopub_15
  buffer_store_dwordx2 v[214:215], v212, s[12:15], s95 offen sc1
L_nopub_15:
  s_mov_b64 exec, -1
  s_and_b32 s38, s24, 3
  s_lshr_b32 s39, s24, 2
  s_and_b32 s36, s30, 1
  s_xor_b32 s36, s36, s39
  v_lshlrev_b32 v2, 4, v0
  v_bfe_u32 v4, v0, 2, 2
  v_lshrrev_b32 v3, 4, v0
  v_lshl_add_u32 v4, v3, 2, v4
  v_and_b32 v6, 3, v0
  v_lshlrev_b32 v6, 3, v6
  v_lshl_add_u32 v6, v4, 7, v6
  s_cmp_eq_u32 s39, 0
  s_cselect_b32 s3, 40960, 0
  s_lshl_b32 s99, s39, 16
  s_add_u32 s99, s99, 40960
  v_add_u32 v6, s3, v6
  v_bfe_u32 v7, v4, 1, 2
  v_xor_b32 v3, 0, v7
  v_lshl_add_u32 v184, v3, 5, v6
  v_add_u32 v188, s99, v184
  v_xor_b32 v3, 1, v7
  v_lshl_add_u32 v185, v3, 5, v6
  v_add_u32 v189, s99, v185
  v_xor_b32 v3, 2, v7
  v_lshl_add_u32 v186, v3, 5, v6
  v_add_u32 v190, s99, v186
  v_xor_b32 v3, 3, v7
  v_lshl_add_u32 v187, v3, 5, v6
  v_add_u32 v191, s99, v187
  s_lshl_b32 s3, s24, 12
  s_add_u32 s3, s3, 131072
  v_add_u32 v178, s3, v2
  s_xor_b32 s3, s3, 16384
  v_add_u32 v179, s3, v2
  s_lshl_b32 s3, s39, 2
  s_add_u32 s3, s3, 161792
  v_mov_b32 v180, s3
  s_lshl_b32 s3, s30, 11
  s_lshl_b32 s99, s31, 7
  s_add_u32 s3, s3, s99
  s_lshl_b32 s99, s36, 6
  s_add_u32 s3, s3, s99
  s_add_u32 s3, s3, 13762560
  v_and_b32 v181, 7, v0
  v_lshl_add_u32 v181, v181, 3, s3
  s_lshl_b32 s3, s31, 8
  s_add_u32 s3, s3, 13639680
  s_lshl_b32 s99, s30, 8
  s_add_u32 s99, s99, 13647872
  v_and_b32 v183, 16, v0
  v_cmp_ne_u32 vcc, 0, v183
  v_mov_b32 v182, s3
  v_mov_b32 v183, s99
  v_cndmask_b32 v183, v182, v183, vcc
  v_and_b32 v182, 15, v0
  v_lshl_add_u32 v182, v182, 3, v183
  v_mov_b32 v183, 1
  s_lshl_b32 s98, s30, 3
  s_lshl_b32 s3, s38, 1
  s_add_u32 s98, s98, s3
  s_add_u32 s98, s98, s39
  s_lshl_b32 s32, s98, 15
  s_lshl_b32 s3, s36, 14
  s_add_u32 s32, s32, s3
  s_xor_b32 s33, s32, 32768
  v_and_b32 v3, 15, v0
  v_lshrrev_b32 v4, 4, v0
  v_lshlrev_b32 v6, 3, v3
  v_lshl_add_u32 v5, v4, 14, v6
  s_lshl_b32 s3, s98, 7
  s_add_u32 s35, s3, 12582912
  s_lshl_b32 s34, s31, 18
  s_add_u32 s34, s34, s3
  s_add_u32 s34, s34, 8388608
  v_lshlrev_b32 v7, 11, v3
  v_and_b32 v3, 1, v4
  v_lshl_add_u32 v7, v3, 5, v7
  v_lshrrev_b32 v3, 1, v4
  v_lshl_add_u32 v7, v3, 4, v7
  s_lshl_b32 s37, s98, 15
  s_lshl_b32 s3, s31, 7
  s_add_u32 s37, s37, s3
  s_mov_b32 s58, 0
L_spin_16:
  ds_read_b32 v216, v210 offset:56
  s_waitcnt lgkmcnt(0)
  v_readfirstlane_b32 s59, v216
  s_add_u32 s58, s58, 1
  s_cmp_eq_u32 s59, 4
  s_cbranch_scc1 L_spun_17
  s_sleep 2
  s_cmp_lt_u32 s58, 4194304
  s_cbranch_scc1 L_spin_16
L_spun_17:
  s_xor_b32 s61, s62, 0x100000
  s_add_u32 m0, s63, 0
  s_add_u32 s60, s61, 0
  buffer_load_dwordx4 v241, s[16:19], s60 offen lds
  s_add_u32 m0, s63, 4096
  s_add_u32 s60, s61, 65536
  buffer_load_dwordx4 v241, s[16:19], s60 offen lds
  s_add_u32 m0, s63, 8192
  s_add_u32 s60, s61, 131072
  buffer_load_dwordx4 v241, s[16:19], s60 offen lds
  s_add_u32 m0, s63, 12288
  s_add_u32 s60, s61, 196608
  buffer_load_dwordx4 v241, s[16:19], s60 offen lds
  s_add_u32 m0, s63, 16384
  s_add_u32 s60, s61, 262144
  buffer_load_dwordx4 v241, s[16:19], s60 offen lds
  s_add_u32 m0, s63, 20480
  s_add_u32 s60, s61, 327680
  buffer_load_dwordx4 v241, s[16:19], s60 offen lds
  s_add_u32 m0, s63, 24576
  s_add_u32 s60, s61, 393216
  buffer_load_dwordx4 v241, s[16:19], s60 offen lds
  s_add_u32 m0, s63, 28672
  s_add_u32 s60, s61, 458752
  buffer_load_dwordx4 v241, s[16:19], s60 offen lds
  s_add_u32 m0, s63, 32768
  s_add_u32 s60, s61, 524288
  buffer_load_dwordx4 v241, s[16:19], s60 offen lds
  s_add_u32 m0, s63, 36864
  s_add_u32 s60, s61, 589824
  buffer_load_dwordx4 v241, s[16:19], s60 offen lds
  s_add_u32 m0, s63, 106496
  s_add_u32 s60, s61, 655360
  buffer_load_dwordx4 v241, s[16:19], s60 offen lds
  s_add_u32 m0, s63, 110592
  s_add_u32 s60, s61, 720896
  buffer_load_dwordx4 v241, s[16:19], s60 offen lds
  s_add_u32 m0, s63, 114688
  s_add_u32 s60, s61, 786432
  buffer_load_dwordx4 v241, s[16:19], s60 offen lds
  s_add_u32 m0, s63, 118784
  s_add_u32 s60, s61, 851968
  buffer_load_dwordx4 v241, s[16:19], s60 offen lds
  s_add_u32 m0, s63, 122880
  s_add_u32 s60, s61, 917504
  buffer_load_dwordx4 v241, s[16:19], s60 offen lds
  s_add_u32 m0, s63, 126976
  s_add_u32 s60, s61, 983040
  buffer_load_dwordx4 v241, s[16:19], s60 offen lds
  v_readfirstlane_b32 s96, v214
  v_readfirstlane_b32 s97, v215
  s_waitcnt vmcnt(0)
  s_mov_b64 exec, 1
  ds_add_u32 v210, v211 offset:84
  s_mov_b64 exec, -1
  s_branch L_phaseD
L_x:
  s_setprio 3
  s_and_b32 s32, s24, 1
  s_lshr_b32 s33, s24, 1
  s_lshl_b32 s34, s28, 1
  s_add_u32 s34, s34, s33
  v_and_b32 v2, 15, v0
  v_lshrrev_b32 v3, 4, v0
  v_lshrrev_b32 v4, 1, v2
  v_and_b32 v4, 7, v4
  s_lshl_b32 s3, s32, 13
  v_lshlrev_b32 v5, 7, v2
  v_add_u32 v5, s3, v5
  v_or_b32 v6, 0, v3
  v_xor_b32 v6, v6, v4
  v_lshl_add_u32 v184, v6, 4, v5
  v_add_u32 v186, 81920, v184
  v_or_b32 v6, 4, v3
  v_xor_b32 v6, v6, v4
  v_lshl_add_u32 v185, v6, 4, v5
  v_add_u32 v187, 81920, v185
  v_bfe_u32 v4, v0, 2, 2
  v_and_b32 v6, 3, v0
  v_lshlrev_b32 v7, 3, v6
  v_bfe_u32 v6, v0, 3, 2
  v_lshlrev_b32 v6, 5, v6
  s_lshl_b32 s3, s33, 6
  v_add_u32 v7, s3, v7
  v_lshl_add_u32 v4, v3, 3, v4
  v_lshl_add_u32 v7, v4, 7, v7
  v_xor_b32 v4, v7, v6
  v_xor_b32 v5, 32, v4
  v_add_u32 v188, 16384, v4
  v_add_u32 v189, 16384, v5
  v_add_u32 v190, 98304, v4
  v_add_u32 v191, 98304, v5
  v_lshlrev_b32 v2, 4, v0
  v_lshlrev_b32 v5, 2, v0
  s_mul_i32 s37, s24, 3072
  s_xor_b32 s38, s24, 1
  s_mul_i32 s39, s38, 3072
  s_add_u32 s37, s37, 110592
  s_add_u32 s39, s39, 110592
  v_add_u32 v3, s37, v2
  v_add_u32 v4, s39, v2
  v_add_u32 v6, s37, v5
  v_add_u32 v7, s39, v5
  s_lshl_b32 s3, s24, 2
  s_add_u32 s3, s3, 161792
  v_mov_b32 v208, s3
  s_lshl_b32 s3, s38, 2
  s_add_u32 s3, s3, 161792
  v_mov_b32 v209, s3
  v_mov_b32 v210, 161792
  v_mov_b32 v211, 1
  s_mov_b32 s36, 0x358637bd
  s_lshl_b32 s60, s34, 1
  s_add_u32 s60, s60, s32
  s_lshl_b32 s60, s60, 14
  s_add_u32 s60, s60, 4194304
  s_lshl_b32 s3, s27, 10
  s_add_u32 s61, s60, s3
  s_lshl_b32 s62, s34, 11
  s_add_u32 s62, s62, 6291456
  s_lshl_b32 s3, s27, 2
  s_add_u32 s63, s62, s3
  v_mov_b32 v224, 0x3f803f80
  v_mov_b32 v225, 0x3f803f80
  v_mov_b32 v226, 0x3f803f80
  v_mov_b32 v227, 0x3f803f80
  s_mul_i32 s35, s24, 8704
  s_add_u32 s35, s35, 122880
  s_movk_i32 s3, 528
  v_and_b32 v8, 15, v0
  v_and_b32 v9, 48, v0
  v_add_u32 v9, s35, v9
  v_and_b32 v10, 3, v0
  v_lshrrev_b32 v11, 4, v0
  v_lshrrev_b32 v12, 2, v8
  v_lshl_add_u32 v196, v0, 3, s35
  v_add_u32 v197, 2112, v196
  v_add_u32 v198, 4224, v196
  v_add_u32 v199, 6336, v196
  v_mad_u32_u24 v192, v8, s3, v9
  v_lshl_add_u32 v13, v12, 1, v10
  v_mad_u32_u24 v193, v13, s3, v9
  v_and_b32 v13, 1, v12
  v_lshl_add_u32 v13, v13, 1, v10
  v_lshrrev_b32 v16, 1, v12
  v_lshl_add_u32 v13, v13, 1, v16
  v_mad_u32_u24 v194, v13, s3, v9
  v_and_b32 v13, 1, v12
  v_lshl_add_u32 v13, v10, 1, v13
  v_mad_u32_u24 v13, v16, 6, v13
  v_mad_u32_u24 v195, v13, s3, v9
  v_and_b32 v200, 31, v0
  v_lshl_add_u32 v200, v200, 2, s35
  v_lshrrev_b32 v13, 5, v0
  v_mul_u32_u24 v13, 4480, v13
  v_add_u32 v200, v200, v13
  v_lshl_add_u32 v13, v8, 5, s35
  v_lshrrev_b32 v201, 1, v11
  v_lshl_add_u32 v201, v201, 9, v13
  v_and_b32 v16, 1, v11
  v_lshl_add_u32 v201, v16, 4, v201
  v_lshl_add_u32 v202, v11, 3, v13
  v_add_u32 v203, 4480, v202
  v_lshl_add_u32 v204, v11, 9, v13
  v_mov_b32 v205, 0
  s_waitcnt vmcnt(2)
  v_lshlrev_b32 v88, 16, v38
  v_mul_f32 v88, s56, v88
  v_exp_f32 v88, v88
  v_lshlrev_b32 v89, 16, v34
  v_and_b32 v90, 0xffff0000, v34
  v_mul_f32 v89, s56, v89
  v_mul_f32 v90, s56, v90
  v_exp_f32 v89, v89
  v_exp_f32 v90, v90
  v_lshlrev_b32 v64, 16, v36
  v_lshlrev_b32 v65, 16, v37
  v_and_b32 v66, 0xffff0000, v36
  v_and_b32 v67, 0xffff0000, v37
  v_cvt_pk_bf16_f32 v88, v88, v88
  v_cvt_pk_bf16_f32 v89, v89, v90
  v_max3_f32 v93, |v64|, |v65|, |v66|
  v_max_f32_e64 v93, v93, |v67|
  v_lshlrev_b32 v94, 16, v88
  v_lshlrev_b32 v80, 16, v89
  v_and_b32 v81, 0xffff0000, v89
  v_max_f32_dpp v93, v93, v93 quad_perm:[1,0,3,2] row_mask:0xf bank_mask:0xf
  v_lshlrev_b32 v82, 16, v35
  v_and_b32 v83, 0xffff0000, v35
  v_max_f32_dpp v93, v93, v93 quad_perm:[2,3,0,1] row_mask:0xf bank_mask:0xf
  v_mul_f32 v80, v80, v94
  v_mul_f32 v82, v82, v94
  v_max_f32_dpp v93, v93, v93 row_half_mirror row_mask:0xf bank_mask:0xf
  v_mul_f32 v81, v81, v94
  v_mul_f32 v83, v83, v94
  v_max_f32_dpp v93, v93, v93 row_mirror row_mask:0xf bank_mask:0xf
  v_mul_f32_e64 v80, -v80, s56
  v_mul_f32 v82, s57, v82
  v_mul_f32_e64 v81, -v81, s56
  v_mul_f32 v83, s57, v83
  v_readlane_b32 s94, v93, 0
  v_readlane_b32 s95, v93, 16
  v_readlane_b32 s96, v93, 32
  v_readlane_b32 s97, v93, 48
  v_mul_f32 v88, 0x41800000, v80
  v_mul_f32 v89, 0x41800000, v82
  v_exp_f32 v88, v88
  v_fract_f32 v89, v89
  v_mul_f32 v90, 0x41800000, v81
  v_mul_f32 v91, 0x41800000, v83
  v_exp_f32 v90, v90
  v_fract_f32 v91, v91
  v_cos_f32 v56, v89
  v_sin_f32 v57, v89
  v_cos_f32 v58, v91
  v_sin_f32 v59, v91
  v_mul_f32 v56, v56, v88
  v_mul_f32 v57, v57, v88
  v_mul_f32 v58, v58, v90
  v_mul_f32 v59, v59, v90
  s_max_u32 s94, s94, s95
  s_max_u32 s96, s96, s97
  s_max_u32 s94, s94, s96
  s_lshr_b32 s94, s94, 23
  s_max_u32 s94, s94, 14
  s_min_u32 s94, s94, 254
  s_sub_u32 s95, 267, s94
  s_lshl_b32 s95, s95, 23
  s_sub_u32 s96, s94, 13
  s_lshl_b32 s96, s96, 23
  v_exp_f32 v88, v80
  v_fract_f32 v89, v82
  v_exp_f32 v90, v81
  v_fract_f32 v91, v83
  v_cos_f32 v40, v89
  v_sin_f32 v41, v89
  v_cos_f32 v42, v91
  v_sin_f32 v43, v91
  v_mul_f32 v40, v40, v88
  v_mul_f32 v41, v41, v88
  v_mul_f32 v42, v42, v90
  v_mul_f32 v43, v43, v90
  v_mul_f32 v88, 0x43800000, v80
  v_mul_f32 v89, 0x43800000, v82
  v_exp_f32 v88, v88
  v_fract_f32 v89, v89
  v_mul_f32 v90, 0x43800000, v81
  v_mul_f32 v91, 0x43800000, v83
  v_exp_f32 v90, v90
  v_fract_f32 v91, v91
  v_cos_f32 v60, v89
  v_sin_f32 v61, v89
  v_cos_f32 v62, v91
  v_sin_f32 v63, v91
  v_mul_f32 v60, v60, v88
  v_mul_f32 v61, v61, v88
  v_mul_f32 v62, v62, v90
  v_mul_f32 v63, v63, v90
  v_mul_f32 v64, s95, v64
  v_mul_f32 v65, s95, v65
  v_mul_f32 v66, s95, v66
  v_mul_f32 v67, s95, v67
  v_mul_f32 v95, s96, v94
  v_mul_f32 v95, 0x39000000, v95
  v_mov_b32 v72, 0x46800000
  v_mov_b32 v73, 0
  v_mov_b32 v74, 0x46800000
  v_mov_b32 v75, 0
  v_mul_f32 v8, 0x46800000, v56
  v_mul_f32 v9, 0xc6800000, v57
  v_mul_f32 v10, 0x46800000, v58
  v_mul_f32 v11, 0xc6800000, v59
  v_pk_mul_f32 v[76:77], v[56:57], v[56:57] op_sel:[0,0] op_sel_hi:[1,0]
  v_pk_mul_f32 v[78:79], v[58:59], v[58:59] op_sel:[0,0] op_sel_hi:[1,0]
  v_pk_mul_f32 v[16:17], v[40:41], v[40:41] op_sel:[0,0] op_sel_hi:[1,0]
  v_pk_mul_f32 v[18:19], v[42:43], v[42:43] op_sel:[0,0] op_sel_hi:[1,0]
  v_pk_mul_f32 v[20:21], v[60:61], v[60:61] op_sel:[0,0] op_sel_hi:[1,0]
  v_pk_mul_f32 v[22:23], v[62:63], v[62:63] op_sel:[0,0] op_sel_hi:[1,0]
  v_pk_fma_f32 v[24:25], v[56:57], v[56:57], v[76:77] op_sel:[1,1,0] op_sel_hi:[0,1,1] neg_lo:[1,0,0]
  v_pk_fma_f32 v[26:27], v[58:59], v[58:59], v[78:79] op_sel:[1,1,0] op_sel_hi:[0,1,1] neg_lo:[1,0,0]
  v_pk_fma_f32 v[44:45], v[40:41], v[40:41], v[16:17] op_sel:[1,1,0] op_sel_hi:[0,1,1] neg_lo:[1,0,0]
  v_pk_fma_f32 v[46:47], v[42:43], v[42:43], v[18:19] op_sel:[1,1,0] op_sel_hi:[0,1,1] neg_lo:[1,0,0]
  v_pk_fma_f32 v[28:29], v[60:61], v[60:61], v[20:21] op_sel:[1,1,0] op_sel_hi:[0,1,1] neg_lo:[1,0,0]
  v_pk_fma_f32 v[30:31], v[62:63], v[62:63], v[22:23] op_sel:[1,1,0] op_sel_hi:[0,1,1] neg_lo:[1,0,0]
  v_cvt_pk_f16_f32 v84, v72, v73
  v_cvt_pk_f16_f32 v85, v74, v75
  v_cvt_pk_f16_f32 v86, v8, v9
  v_cvt_pk_f16_f32 v87, v10, v11
  ds_write2_b64 v196, v[84:85], v[86:87] offset0:0 offset1:66
  v_pk_mul_f32 v[76:77], v[72:73], v[24:25] op_sel:[0,0] op_sel_hi:[1,0]
  v_pk_mul_f32 v[78:79], v[74:75], v[26:27] op_sel:[0,0] op_sel_hi:[1,0]
  v_pk_mul_f32 v[16:17], v[8:9], v[24:25] op_sel:[0,0] op_sel_hi:[1,0]
  v_pk_mul_f32 v[18:19], v[10:11], v[26:27] op_sel:[0,0] op_sel_hi:[1,0]
  v_pk_fma_f32 v[72:73], v[72:73], v[24:25], v[76:77] op_sel:[1,1,0] op_sel_hi:[0,1,1] neg_hi:[1,0,0]
  v_pk_fma_f32 v[74:75], v[74:75], v[26:27], v[78:79] op_sel:[1,1,0] op_sel_hi:[0,1,1] neg_hi:[1,0,0]
  v_pk_fma_f32 v[8:9], v[8:9], v[24:25], v[16:17] op_sel:[1,1,0] op_sel_hi:[0,1,1] neg_hi:[1,0,0]
  v_pk_fma_f32 v[10:11], v[10:11], v[26:27], v[18:19] op_sel:[1,1,0] op_sel_hi:[0,1,1] neg_hi:[1,0,0]
  v_cvt_pk_f16_f32 v84, v72, v73
  v_cvt_pk_f16_f32 v85, v74, v75
  v_cvt_pk_f16_f32 v86, v8, v9
  v_cvt_pk_f16_f32 v87, v10, v11
  ds_write2_b64 v196, v[84:85], v[86:87] offset0:132 offset1:198
  v_pk_mul_f32 v[76:77], v[72:73], v[24:25] op_sel:[0,0] op_sel_hi:[1,0]
  v_pk_mul_f32 v[78:79], v[74:75], v[26:27] op_sel:[0,0] op_sel_hi:[1,0]
  v_pk_mul_f32 v[16:17], v[8:9], v[24:25] op_sel:[0,0] op_sel_hi:[1,0]
  v_pk_mul_f32 v[18:19], v[10:11], v[26:27] op_sel:[0,0] op_sel_hi:[1,0]
  v_pk_fma_f32 v[72:73], v[72:73], v[24:25], v[76:77] op_sel:[1,1,0] op_sel_hi:[0,1,1] neg_hi:[1,0,0]
  v_pk_fma_f32 v[74:75], v[74:75], v[26:27], v[78:79] op_sel:[1,1,0] op_sel_hi:[0,1,1] neg_hi:[1,0,0]
  v_pk_fma_f32 v[8:9], v[8:9], v[24:25], v[16:17] op_sel:[1,1,0] op_sel_hi:[0,1,1] neg_hi:[1,0,0]
  v_pk_fma_f32 v[10:11], v[10:11], v[26:27], v[18:19] op_sel:[1,1,0] op_sel_hi:[0,1,1] neg_hi:[1,0,0]
  v_cvt_pk_f16_f32 v84, v72, v73
  v_cvt_pk_f16_f32 v85, v74, v75
  v_cvt_pk_f16_f32 v86, v8, v9
  v_cvt_pk_f16_f32 v87, v10, v11
  ds_write2_b64 v197, v[84:85], v[86:87] offset0:0 offset1:66
  v_pk_mul_f32 v[76:77], v[72:73], v[24:25] op_sel:[0,0] op_sel_hi:[1,0]
  v_pk_mul_f32 v[78:79], v[74:75], v[26:27] op_sel:[0,0] op_sel_hi:[1,0]
  v_pk_mul_f32 v[16:17], v[8:9], v[24:25] op_sel:[0,0] op_sel_hi:[1,0]
  v_pk_mul_f32 v[18:19], v[10:11], v[26:27] op_sel:[0,0] op_sel_hi:[1,0]
  v_pk_fma_f32 v[72:73], v[72:73], v[24:25], v[76:77] op_sel:[1,1,0] op_sel_hi:[0,1,1] neg_hi:[1,0,0]
  v_pk_fma_f32 v[74:75], v[74:75], v[26:27], v[78:79] op_sel:[1,1,0] op_sel_hi:[0,1,1] neg_hi:[1,0,0]
  v_pk_fma_f32 v[8:9], v[8:9], v[24:25], v[16:17] op_sel:[1,1,0] op_sel_hi:[0,1,1] neg_hi:[1,0,0]
  v_pk_fma_f32 v[10:11], v[10:11], v[26:27], v[18:19] op_sel:[1,1,0] op_sel_hi:[0,1,1] neg_hi:[1,0,0]
  v_cvt_pk_f16_f32 v84, v72, v73
  v_cvt_pk_f16_f32 v85, v74, v75
  v_cvt_pk_f16_f32 v86, v8, v9
  v_cvt_pk_f16_f32 v87, v10, v11
  ds_write2_b64 v197, v[84:85], v[86:87] offset0:132 offset1:198
  v_pk_mul_f32 v[76:77], v[72:73], v[24:25] op_sel:[0,0] op_sel_hi:[1,0]
  v_pk_mul_f32 v[78:79], v[74:75], v[26:27] op_sel:[0,0] op_sel_hi:[1,0]
  v_pk_mul_f32 v[16:17], v[8:9], v[24:25] op_sel:[0,0] op_sel_hi:[1,0]
  v_pk_mul_f32 v[18:19], v[10:11], v[26:27] op_sel:[0,0] op_sel_hi:[1,0]
  v_pk_fma_f32 v[72:73], v[72:73], v[24:25], v[76:77] op_sel:[1,1,0] op_sel_hi:[0,1,1] neg_hi:[1,0,0]
  v_pk_fma_f32 v[74:75], v[74:75], v[26:27], v[78:79] op_sel:[1,1,0] op_sel_hi:[0,1,1] neg_hi:[1,0,0]
  v_pk_fma_f32 v[8:9], v[8:9], v[24:25], v[16:17] op_sel:[1,1,0] op_sel_hi:[0,1,1] neg_hi:[1,0,0]
  v_pk_fma_f32 v[10:11], v[10:11], v[26:27], v[18:19] op_sel:[1,1,0] op_sel_hi:[0,1,1] neg_hi:[1,0,0]
  v_cvt_pk_f16_f32 v84, v72, v73
  v_cvt_pk_f16_f32 v85, v74, v75
  v_cvt_pk_f16_f32 v86, v8, v9
  v_cvt_pk_f16_f32 v87, v10, v11
  ds_write2_b64 v198, v[84:85], v[86:87] offset0:0 offset1:66
  v_pk_mul_f32 v[76:77], v[72:73], v[24:25] op_sel:[0,0] op_sel_hi:[1,0]
  v_pk_mul_f32 v[78:79], v[74:75], v[26:27] op_sel:[0,0] op_sel_hi:[1,0]
  v_pk_mul_f32 v[16:17], v[8:9], v[24:25] op_sel:[0,0] op_sel_hi:[1,0]
  v_pk_mul_f32 v[18:19], v[10:11], v[26:27] op_sel:[0,0] op_sel_hi:[1,0]
  v_pk_fma_f32 v[72:73], v[72:73], v[24:25], v[76:77] op_sel:[1,1,0] op_sel_hi:[0,1,1] neg_hi:[1,0,0]
  v_pk_fma_f32 v[74:75], v[74:75], v[26:27], v[78:79] op_sel:[1,1,0] op_sel_hi:[0,1,1] neg_hi:[1,0,0]
  v_pk_fma_f32 v[8:9], v[8:9], v[24:25], v[16:17] op_sel:[1,1,0] op_sel_hi:[0,1,1] neg_hi:[1,0,0]
  v_pk_fma_f32 v[10:11], v[10:11], v[26:27], v[18:19] op_sel:[1,1,0] op_sel_hi:[0,1,1] neg_hi:[1,0,0]
  v_cvt_pk_f16_f32 v84, v72, v73
  v_cvt_pk_f16_f32 v85, v74, v75
  v_cvt_pk_f16_f32 v86, v8, v9
  v_cvt_pk_f16_f32 v87, v10, v11
  ds_write2_b64 v198, v[84:85], v[86:87] offset0:132 offset1:198
  v_pk_mul_f32 v[76:77], v[72:73], v[24:25] op_sel:[0,0] op_sel_hi:[1,0]
  v_pk_mul_f32 v[78:79], v[74:75], v[26:27] op_sel:[0,0] op_sel_hi:[1,0]
  v_pk_mul_f32 v[16:17], v[8:9], v[24:25] op_sel:[0,0] op_sel_hi:[1,0]
  v_pk_mul_f32 v[18:19], v[10:11], v[26:27] op_sel:[0,0] op_sel_hi:[1,0]
  v_pk_fma_f32 v[72:73], v[72:73], v[24:25], v[76:77] op_sel:[1,1,0] op_sel_hi:[0,1,1] neg_hi:[1,0,0]
  v_pk_fma_f32 v[74:75], v[74:75], v[26:27], v[78:79] op_sel:[1,1,0] op_sel_hi:[0,1,1] neg_hi:[1,0,0]
  v_pk_fma_f32 v[8:9], v[8:9], v[24:25], v[16:17] op_sel:[1,1,0] op_sel_hi:[0,1,1] neg_hi:[1,0,0]
  v_pk_fma_f32 v[10:11], v[10:11], v[26:27], v[18:19] op_sel:[1,1,0] op_sel_hi:[0,1,1] neg_hi:[1,0,0]
  v_cvt_pk_f16_f32 v84, v72, v73
  v_cvt_pk_f16_f32 v85, v74, v75
  v_cvt_pk_f16_f32 v86, v8, v9
  v_cvt_pk_f16_f32 v87, v10, v11
  ds_write2_b64 v199, v[84:85], v[86:87] offset0:0 offset1:66
  v_pk_mul_f32 v[76:77], v[72:73], v[24:25] op_sel:[0,0] op_sel_hi:[1,0]
  v_pk_mul_f32 v[78:79], v[74:75], v[26:27] op_sel:[0,0] op_sel_hi:[1,0]
  v_pk_mul_f32 v[16:17], v[8:9], v[24:25] op_sel:[0,0] op_sel_hi:[1,0]
  v_pk_mul_f32 v[18:19], v[10:11], v[26:27] op_sel:[0,0] op_sel_hi:[1,0]
  v_pk_fma_f32 v[72:73], v[72:73], v[24:25], v[76:77] op_sel:[1,1,0] op_sel_hi:[0,1,1] neg_hi:[1,0,0]
  v_pk_fma_f32 v[74:75], v[74:75], v[26:27], v[78:79] op_sel:[1,1,0] op_sel_hi:[0,1,1] neg_hi:[1,0,0]
  v_pk_fma_f32 v[8:9], v[8:9], v[24:25], v[16:17] op_sel:[1,1,0] op_sel_hi:[0,1,1] neg_hi:[1,0,0]
  v_pk_fma_f32 v[10:11], v[10:11], v[26:27], v[18:19] op_sel:[1,1,0] op_sel_hi:[0,1,1] neg_hi:[1,0,0]
  v_cvt_pk_f16_f32 v84, v72, v73
  v_cvt_pk_f16_f32 v85, v74, v75
  v_cvt_pk_f16_f32 v86, v8, v9
  v_cvt_pk_f16_f32 v87, v10, v11
  ds_write2_b64 v199, v[84:85], v[86:87] offset0:132 offset1:198
  ds_read_b128 v[96:99], v192 offset:0
  ds_read_b128 v[100:103], v192 offset:64
  ds_read_b128 v[104:107], v192 offset:128
  ds_read_b128 v[108:111], v192 offset:192
  ds_read_b128 v[112:115], v192 offset:256
  ds_read_b128 v[116:119], v192 offset:320
  ds_read_b128 v[120:123], v192 offset:384
  ds_read_b128 v[124:127], v192 offset:448
  v_pk_mul_f32 v[76:77], v[64:65], v[40:41] op_sel:[0,0] op_sel_hi:[1,0]
  v_pk_mul_f32 v[78:79], v[66:67], v[42:43] op_sel:[0,0] op_sel_hi:[1,0]
  v_pk_mul_f32 v[16:17], v[64:65], v[60:61] op_sel:[0,0] op_sel_hi:[1,0]
  v_pk_mul_f32 v[18:19], v[66:67], v[62:63] op_sel:[0,0] op_sel_hi:[1,0]
  v_pk_mul_f32 v[20:21], v[44:45], v[44:45] op_sel:[0,0] op_sel_hi:[1,0]
  v_pk_mul_f32 v[22:23], v[46:47], v[46:47] op_sel:[0,0] op_sel_hi:[1,0]
  v_pk_fma_f32 v[8:9], v[64:65], v[40:41], v[76:77] op_sel:[1,1,0] op_sel_hi:[0,1,1] neg_lo:[1,0,0]
  v_pk_fma_f32 v[10:11], v[66:67], v[42:43], v[78:79] op_sel:[1,1,0] op_sel_hi:[0,1,1] neg_lo:[1,0,0]
  v_pk_fma_f32 v[68:69], v[64:65], v[60:61], v[16:17] op_sel:[1,1,0] op_sel_hi:[0,1,1] neg_lo:[1,0,0]
  v_pk_fma_f32 v[70:71], v[66:67], v[62:63], v[18:19] op_sel:[1,1,0] op_sel_hi:[0,1,1] neg_lo:[1,0,0]
  v_pk_fma_f32 v[48:49], v[44:45], v[44:45], v[20:21] op_sel:[1,1,0] op_sel_hi:[0,1,1] neg_lo:[1,0,0]
  v_pk_fma_f32 v[50:51], v[46:47], v[46:47], v[22:23] op_sel:[1,1,0] op_sel_hi:[0,1,1] neg_lo:[1,0,0]
  v_cvt_pk_f16_f32 v84, v64, v65
  v_cvt_pk_f16_f32 v85, v66, v67
  v_cvt_pk_f16_f32 v86, v8, v9
  v_cvt_pk_f16_f32 v87, v10, v11
  ds_write2_b64 v196, v[84:85], v[86:87] offset0:0 offset1:66
  v_pk_mul_f32 v[76:77], v[64:65], v[44:45] op_sel:[0,0] op_sel_hi:[1,0]
  v_pk_mul_f32 v[78:79], v[66:67], v[46:47] op_sel:[0,0] op_sel_hi:[1,0]
  v_pk_mul_f32 v[16:17], v[8:9], v[44:45] op_sel:[0,0] op_sel_hi:[1,0]
  v_pk_mul_f32 v[18:19], v[10:11], v[46:47] op_sel:[0,0] op_sel_hi:[1,0]
  v_pk_fma_f32 v[72:73], v[64:65], v[44:45], v[76:77] op_sel:[1,1,0] op_sel_hi:[0,1,1] neg_lo:[1,0,0]
  v_pk_fma_f32 v[74:75], v[66:67], v[46:47], v[78:79] op_sel:[1,1,0] op_sel_hi:[0,1,1] neg_lo:[1,0,0]
  v_pk_fma_f32 v[8:9], v[8:9], v[44:45], v[16:17] op_sel:[1,1,0] op_sel_hi:[0,1,1] neg_lo:[1,0,0]
  v_pk_fma_f32 v[10:11], v[10:11], v[46:47], v[18:19] op_sel:[1,1,0] op_sel_hi:[0,1,1] neg_lo:[1,0,0]
  v_cvt_pk_f16_f32 v84, v72, v73
  v_cvt_pk_f16_f32 v85, v74, v75
  v_cvt_pk_f16_f32 v86, v8, v9
  v_cvt_pk_f16_f32 v87, v10, v11
  ds_write2_b64 v196, v[84:85], v[86:87] offset0:132 offset1:198
  v_pk_mul_f32 v[76:77], v[72:73], v[44:45] op_sel:[0,0] op_sel_hi:[1,0]
  v_pk_mul_f32 v[78:79], v[74:75], v[46:47] op_sel:[0,0] op_sel_hi:[1,0]
  v_pk_mul_f32 v[16:17], v[8:9], v[44:45] op_sel:[0,0] op_sel_hi:[1,0]
  v_pk_mul_f32 v[18:19], v[10:11], v[46:47] op_sel:[0,0] op_sel_hi:[1,0]
  v_pk_fma_f32 v[72:73], v[72:73], v[44:45], v[76:77] op_sel:[1,1,0] op_sel_hi:[0,1,1] neg_lo:[1,0,0]
  v_pk_fma_f32 v[74:75], v[74:75], v[46:47], v[78:79] op_sel:[1,1,0] op_sel_hi:[0,1,1] neg_lo:[1,0,0]
  v_pk_fma_f32 v[8:9], v[8:9], v[44:45], v[16:17] op_sel:[1,1,0] op_sel_hi:[0,1,1] neg_lo:[1,0,0]
  v_pk_fma_f32 v[10:11], v[10:11], v[46:47], v[18:19] op_sel:[1,1,0] op_sel_hi:[0,1,1] neg_lo:[1,0,0]
  v_cvt_pk_f16_f32 v84, v72, v73
  v_cvt_pk_f16_f32 v85, v74, v75
  v_cvt_pk_f16_f32 v86, v8, v9
  v_cvt_pk_f16_f32 v87, v10, v11
  ds_write2_b64 v197, v[84:85], v[86:87] offset0:0 offset1:66
  v_pk_mul_f32 v[76:77], v[72:73], v[44:45] op_sel:[0,0] op_sel_hi:[1,0]
  v_pk_mul_f32 v[78:79], v[74:75], v[46:47] op_sel:[0,0] op_sel_hi:[1,0]
  v_pk_mul_f32 v[16:17], v[8:9], v[44:45] op_sel:[0,0] op_sel_hi:[1,0]
  v_pk_mul_f32 v[18:19], v[10:11], v[46:47] op_sel:[0,0] op_sel_hi:[1,0]
  v_pk_fma_f32 v[72:73], v[72:73], v[44:45], v[76:77] op_sel:[1,1,0] op_sel_hi:[0,1,1] neg_lo:[1,0,0]
  v_pk_fma_f32 v[74:75], v[74:75], v[46:47], v[78:79] op_sel:[1,1,0] op_sel_hi:[0,1,1] neg_lo:[1,0,0]
  v_pk_fma_f32 v[8:9], v[8:9], v[44:45], v[16:17] op_sel:[1,1,0] op_sel_hi:[0,1,1] neg_lo:[1,0,0]
  v_pk_fma_f32 v[10:11], v[10:11], v[46:47], v[18:19] op_sel:[1,1,0] op_sel_hi:[0,1,1] neg_lo:[1,0,0]
  v_cvt_pk_f16_f32 v84, v72, v73
  v_cvt_pk_f16_f32 v85, v74, v75
  v_cvt_pk_f16_f32 v86, v8, v9
  v_cvt_pk_f16_f32 v87, v10, v11
  ds_write2_b64 v197, v[84:85], v[86:87] offset0:132 offset1:198
  v_pk_mul_f32 v[76:77], v[72:73], v[44:45] op_sel:[0,0] op_sel_hi:[1,0]
  v_pk_mul_f32 v[78:79], v[74:75], v[46:47] op_sel:[0,0] op_sel_hi:[1,0]
  v_pk_mul_f32 v[16:17], v[8:9], v[44:45] op_sel:[0,0] op_sel_hi:[1,0]
  v_pk_mul_f32 v[18:19], v[10:11], v[46:47] op_sel:[0,0] op_sel_hi:[1,0]
  v_pk_fma_f32 v[72:73], v[72:73], v[44:45], v[76:77] op_sel:[1,1,0] op_sel_hi:[0,1,1] neg_lo:[1,0,0]
  v_pk_fma_f32 v[74:75], v[74:75], v[46:47], v[78:79] op_sel:[1,1,0] op_sel_hi:[0,1,1] neg_lo:[1,0,0]
  v_pk_fma_f32 v[8:9], v[8:9], v[44:45], v[16:17] op_sel:[1,1,0] op_sel_hi:[0,1,1] neg_lo:[1,0,0]
  v_pk_fma_f32 v[10:11], v[10:11], v[46:47], v[18:19] op_sel:[1,1,0] op_sel_hi:[0,1,1] neg_lo:[1,0,0]
  v_cvt_pk_f16_f32 v84, v72, v73
  v_cvt_pk_f16_f32 v85, v74, v75
  v_cvt_pk_f16_f32 v86, v8, v9
  v_cvt_pk_f16_f32 v87, v10, v11
  ds_write2_b64 v198, v[84:85], v[86:87] offset0:0 offset1:66
  v_pk_mul_f32 v[76:77], v[72:73], v[44:45] op_sel:[0,0] op_sel_hi:[1,0]
  v_pk_mul_f32 v[78:79], v[74:75], v[46:47] op_sel:[0,0] op_sel_hi:[1,0]
  v_pk_mul_f32 v[16:17], v[8:9], v[44:45] op_sel:[0,0] op_sel_hi:[1,0]
  v_pk_mul_f32 v[18:19], v[10:11], v[46:47] op_sel:[0,0] op_sel_hi:[1,0]
  v_pk_fma_f32 v[72:73], v[72:73], v[44:45], v[76:77] op_sel:[1,1,0] op_sel_hi:[0,1,1] neg_lo:[1,0,0]
  v_pk_fma_f32 v[74:75], v[74:75], v[46:47], v[78:79] op_sel:[1,1,0] op_sel_hi:[0,1,1] neg_lo:[1,0,0]
  v_pk_fma_f32 v[8:9], v[8:9], v[44:45], v[16:17] op_sel:[1,1,0] op_sel_hi:[0,1,1] neg_lo:[1,0,0]
  v_pk_fma_f32 v[10:11], v[10:11], v[46:47], v[18:19] op_sel:[1,1,0] op_sel_hi:[0,1,1] neg_lo:[1,0,0]
  v_cvt_pk_f16_f32 v84, v72, v73
  v_cvt_pk_f16_f32 v85, v74, v75
  v_cvt_pk_f16_f32 v86, v8, v9
  v_cvt_pk_f16_f32 v87, v10, v11
  ds_write2_b64 v198, v[84:85], v[86:87] offset0:132 offset1:198
  v_pk_mul_f32 v[76:77], v[72:73], v[44:45] op_sel:[0,0] op_sel_hi:[1,0]
  v_pk_mul_f32 v[78:79], v[74:75], v[46:47] op_sel:[0,0] op_sel_hi:[1,0]
  v_pk_mul_f32 v[16:17], v[8:9], v[44:45] op_sel:[0,0] op_sel_hi:[1,0]
  v_pk_mul_f32 v[18:19], v[10:11], v[46:47] op_sel:[0,0] op_sel_hi:[1,0]
  v_pk_fma_f32 v[72:73], v[72:73], v[44:45], v[76:77] op_sel:[1,1,0] op_sel_hi:[0,1,1] neg_lo:[1,0,0]
  v_pk_fma_f32 v[74:75], v[74:75], v[46:47], v[78:79] op_sel:[1,1,0] op_sel_hi:[0,1,1] neg_lo:[1,0,0]
  v_pk_fma_f32 v[8:9], v[8:9], v[44:45], v[16:17] op_sel:[1,1,0] op_sel_hi:[0,1,1] neg_lo:[1,0,0]
  v_pk_fma_f32 v[10:11], v[10:11], v[46:47], v[18:19] op_sel:[1,1,0] op_sel_hi:[0,1,1] neg_lo:[1,0,0]
  v_cvt_pk_f16_f32 v84, v72, v73
  v_cvt_pk_f16_f32 v85, v74, v75
  v_cvt_pk_f16_f32 v86, v8, v9
  v_cvt_pk_f16_f32 v87, v10, v11
  ds_write2_b64 v199, v[84:85], v[86:87] offset0:0 offset1:66
  v_pk_mul_f32 v[76:77], v[72:73], v[44:45] op_sel:[0,0] op_sel_hi:[1,0]
  v_pk_mul_f32 v[78:79], v[74:75], v[46:47] op_sel:[0,0] op_sel_hi:[1,0]
  v_pk_mul_f32 v[16:17], v[8:9], v[44:45] op_sel:[0,0] op_sel_hi:[1,0]
  v_pk_mul_f32 v[18:19], v[10:11], v[46:47] op_sel:[0,0] op_sel_hi:[1,0]
  v_pk_fma_f32 v[72:73], v[72:73], v[44:45], v[76:77] op_sel:[1,1,0] op_sel_hi:[0,1,1] neg_lo:[1,0,0]
  v_pk_fma_f32 v[74:75], v[74:75], v[46:47], v[78:79] op_sel:[1,1,0] op_sel_hi:[0,1,1] neg_lo:[1,0,0]
  v_pk_fma_f32 v[8:9], v[8:9], v[44:45], v[16:17] op_sel:[1,1,0] op_sel_hi:[0,1,1] neg_lo:[1,0,0]
  v_pk_fma_f32 v[10:11], v[10:11], v[46:47], v[18:19] op_sel:[1,1,0] op_sel_hi:[0,1,1] neg_lo:[1,0,0]
  v_cvt_pk_f16_f32 v84, v72, v73
  v_cvt_pk_f16_f32 v85, v74, v75
  v_cvt_pk_f16_f32 v86, v8, v9
  v_cvt_pk_f16_f32 v87, v10, v11
  ds_write2_b64 v199, v[84:85], v[86:87] offset0:132 offset1:198
  ds_read_b128 v[128:131], v192 offset:0
  ds_read_b128 v[132:135], v192 offset:64
  ds_read_b128 v[136:139], v192 offset:128
  ds_read_b128 v[140:143], v192 offset:192
  ds_read_b128 v[144:147], v192 offset:256
  ds_read_b128 v[148:151], v192 offset:320
  ds_read_b128 v[152:155], v192 offset:384
  ds_read_b128 v[156:159], v192 offset:448
  v_pk_mul_f32 v[76:77], v[68:69], v[44:45] op_sel:[0,0] op_sel_hi:[1,0]
  v_pk_mul_f32 v[78:79], v[70:71], v[46:47] op_sel:[0,0] op_sel_hi:[1,0]
  v_pk_mul_f32 v[16:17], v[48:49], v[48:49] op_sel:[0,0] op_sel_hi:[1,0]
  v_pk_mul_f32 v[18:19], v[50:51], v[50:51] op_sel:[0,0] op_sel_hi:[1,0]
  v_pk_mul_f32 v[20:21], v[68:69], v[28:29] op_sel:[0,0] op_sel_hi:[1,0]
  v_pk_mul_f32 v[22:23], v[70:71], v[30:31] op_sel:[0,0] op_sel_hi:[1,0]
  v_pk_fma_f32 v[8:9], v[68:69], v[44:45], v[76:77] op_sel:[1,1,0] op_sel_hi:[0,1,1] neg_lo:[1,0,0]
  v_pk_fma_f32 v[10:11], v[70:71], v[46:47], v[78:79] op_sel:[1,1,0] op_sel_hi:[0,1,1] neg_lo:[1,0,0]
  v_pk_fma_f32 v[52:53], v[48:49], v[48:49], v[16:17] op_sel:[1,1,0] op_sel_hi:[0,1,1] neg_lo:[1,0,0]
  v_pk_fma_f32 v[54:55], v[50:51], v[50:51], v[18:19] op_sel:[1,1,0] op_sel_hi:[0,1,1] neg_lo:[1,0,0]
  v_pk_fma_f32 v[12:13], v[68:69], v[28:29], v[20:21] op_sel:[1,1,0] op_sel_hi:[0,1,1] neg_lo:[1,0,0]
  v_pk_fma_f32 v[14:15], v[70:71], v[30:31], v[22:23] op_sel:[1,1,0] op_sel_hi:[0,1,1] neg_lo:[1,0,0]
  v_cvt_pk_f16_f32 v84, v68, v69
  v_cvt_pk_f16_f32 v85, v70, v71
  v_cvt_pk_f16_f32 v86, v8, v9
  v_cvt_pk_f16_f32 v87, v10, v11
  ds_write2_b64 v196, v[84:85], v[86:87] offset0:0 offset1:66
  v_pk_mul_f32 v[76:77], v[68:69], v[48:49] op_sel:[0,0] op_sel_hi:[1,0]
  v_pk_mul_f32 v[78:79], v[70:71], v[50:51] op_sel:[0,0] op_sel_hi:[1,0]
  v_pk_mul_f32 v[16:17], v[8:9], v[48:49] op_sel:[0,0] op_sel_hi:[1,0]
  v_pk_mul_f32 v[18:19], v[10:11], v[50:51] op_sel:[0,0] op_sel_hi:[1,0]
  v_pk_fma_f32 v[72:73], v[68:69], v[48:49], v[76:77] op_sel:[1,1,0] op_sel_hi:[0,1,1] neg_lo:[1,0,0]
  v_pk_fma_f32 v[74:75], v[70:71], v[50:51], v[78:79] op_sel:[1,1,0] op_sel_hi:[0,1,1] neg_lo:[1,0,0]
  v_pk_fma_f32 v[8:9], v[8:9], v[48:49], v[16:17] op_sel:[1,1,0] op_sel_hi:[0,1,1] neg_lo:[1,0,0]
  v_pk_fma_f32 v[10:11], v[10:11], v[50:51], v[18:19] op_sel:[1,1,0] op_sel_hi:[0,1,1] neg_lo:[1,0,0]
  v_cvt_pk_f16_f32 v84, v72, v73
  v_cvt_pk_f16_f32 v85, v74, v75
  v_cvt_pk_f16_f32 v86, v8, v9
  v_cvt_pk_f16_f32 v87, v10, v11
  ds_write2_b64 v196, v[84:85], v[86:87] offset0:132 offset1:198
  v_pk_mul_f32 v[76:77], v[72:73], v[48:49] op_sel:[0,0] op_sel_hi:[1,0]
  v_pk_mul_f32 v[78:79], v[74:75], v[50:51] op_sel:[0,0] op_sel_hi:[1,0]
  v_pk_mul_f32 v[16:17], v[8:9], v[48:49] op_sel:[0,0] op_sel_hi:[1,0]
  v_pk_mul_f32 v[18:19], v[10:11], v[50:51] op_sel:[0,0] op_sel_hi:[1,0]
  v_pk_fma_f32 v[72:73], v[72:73], v[48:49], v[76:77] op_sel:[1,1,0] op_sel_hi:[0,1,1] neg_lo:[1,0,0]
  v_pk_fma_f32 v[74:75], v[74:75], v[50:51], v[78:79] op_sel:[1,1,0] op_sel_hi:[0,1,1] neg_lo:[1,0,0]
  v_pk_fma_f32 v[8:9], v[8:9], v[48:49], v[16:17] op_sel:[1,1,0] op_sel_hi:[0,1,1] neg_lo:[1,0,0]
  v_pk_fma_f32 v[10:11], v[10:11], v[50:51], v[18:19] op_sel:[1,1,0] op_sel_hi:[0,1,1] neg_lo:[1,0,0]
  v_cvt_pk_f16_f32 v84, v72, v73
  v_cvt_pk_f16_f32 v85, v74, v75
  v_cvt_pk_f16_f32 v86, v8, v9
  v_cvt_pk_f16_f32 v87, v10, v11
  ds_write2_b64 v197, v[84:85], v[86:87] offset0:0 offset1:66
  v_pk_mul_f32 v[76:77], v[72:73], v[48:49] op_sel:[0,0] op_sel_hi:[1,0]
  v_pk_mul_f32 v[78:79], v[74:75], v[50:51] op_sel:[0,0] op_sel_hi:[1,0]
  v_pk_mul_f32 v[16:17], v[8:9], v[48:49] op_sel:[0,0] op_sel_hi:[1,0]
  v_pk_mul_f32 v[18:19], v[10:11], v[50:51] op_sel:[0,0] op_sel_hi:[1,0]
  v_pk_fma_f32 v[72:73], v[72:73], v[48:49], v[76:77] op_sel:[1,1,0] op_sel_hi:[0,1,1] neg_lo:[1,0,0]
  v_pk_fma_f32 v[74:75], v[74:75], v[50:51], v[78:79] op_sel:[1,1,0] op_sel_hi:[0,1,1] neg_lo:[1,0,0]
  v_pk_fma_f32 v[8:9], v[8:9], v[48:49], v[16:17] op_sel:[1,1,0] op_sel_hi:[0,1,1] neg_lo:[1,0,0]
  v_pk_fma_f32 v[10:11], v[10:11], v[50:51], v[18:19] op_sel:[1,1,0] op_sel_hi:[0,1,1] neg_lo:[1,0,0]
  v_cvt_pk_f16_f32 v84, v72, v73
  v_cvt_pk_f16_f32 v85, v74, v75
  v_cvt_pk_f16_f32 v86, v8, v9
  v_cvt_pk_f16_f32 v87, v10, v11
  ds_write2_b64 v197, v[84:85], v[86:87] offset0:132 offset1:198
  v_pk_mul_f32 v[76:77], v[72:73], v[48:49] op_sel:[0,0] op_sel_hi:[1,0]
  v_pk_mul_f32 v[78:79], v[74:75], v[50:51] op_sel:[0,0] op_sel_hi:[1,0]
  v_pk_fma_f32 v[72:73], v[72:73], v[48:49], v[76:77] op_sel:[1,1,0] op_sel_hi:[0,1,1] neg_lo:[1,0,0]
  v_pk_fma_f32 v[74:75], v[74:75], v[50:51], v[78:79] op_sel:[1,1,0] op_sel_hi:[0,1,1] neg_lo:[1,0,0]
  v_cvt_pk_f16_f32 v84, v72, v73
  v_cvt_pk_f16_f32 v85, v74, v75
  ds_write_b64 v196, v[84:85] offset:4224
  v_pk_mul_f32 v[76:77], v[64:65], v[28:29] op_sel:[0,0] op_sel_hi:[1,0]
  v_pk_mul_f32 v[78:79], v[66:67], v[30:31] op_sel:[0,0] op_sel_hi:[1,0]
  v_pk_fma_f32 v[68:69], v[64:65], v[28:29], v[76:77] op_sel:[1,1,0] op_sel_hi:[0,1,1] neg_lo:[1,0,0]
  v_pk_fma_f32 v[70:71], v[66:67], v[30:31], v[78:79] op_sel:[1,1,0] op_sel_hi:[0,1,1] neg_lo:[1,0,0]
  s_waitcnt lgkmcnt(5)
  v_mfma_f32_16x16x32_f16 v[160:163], v[128:131], v[96:99], 0
  v_mfma_f32_16x16x32_f16 v[160:163], v[132:135], v[100:103], v[160:163]
  v_mfma_f32_16x16x32_f16 v[160:163], v[136:139], v[104:107], v[160:163]
  v_mfma_f32_16x16x32_f16 v[160:163], v[140:143], v[108:111], v[160:163]
  v_mfma_f32_16x16x32_f16 v[160:163], v[144:147], v[112:115], v[160:163]
  v_mfma_f32_16x16x32_f16 v[160:163], v[148:151], v[116:119], v[160:163]
  v_mfma_f32_16x16x32_f16 v[160:163], v[152:155], v[120:123], v[160:163]
  v_mfma_f32_16x16x32_f16 v[160:163], v[156:159], v[124:127], v[160:163]
  ds_read_b128 v[128:131], v193 offset:0
  ds_read_b128 v[132:135], v193 offset:64
  ds_read_b128 v[136:139], v193 offset:128
  ds_read_b128 v[140:143], v193 offset:192
  ds_read_b128 v[144:147], v193 offset:256
  ds_read_b128 v[148:151], v193 offset:320
  ds_read_b128 v[152:155], v193 offset:384
  ds_read_b128 v[156:159], v193 offset:448
  v_cvt_pk_f16_f32 v84, v68, v69
  v_cvt_pk_f16_f32 v85, v70, v71
  v_cvt_pk_f16_f32 v86, v12, v13
  v_cvt_pk_f16_f32 v87, v14, v15
  ds_write2_b64 v196, v[84:85], v[86:87] offset0:0 offset1:66
  v_pk_mul_f32 v[76:77], v[68:69], v[48:49] op_sel:[0,0] op_sel_hi:[1,0]
  v_pk_mul_f32 v[78:79], v[70:71], v[50:51] op_sel:[0,0] op_sel_hi:[1,0]
  v_pk_mul_f32 v[16:17], v[12:13], v[48:49] op_sel:[0,0] op_sel_hi:[1,0]
  v_pk_mul_f32 v[18:19], v[14:15], v[50:51] op_sel:[0,0] op_sel_hi:[1,0]
  v_pk_fma_f32 v[72:73], v[68:69], v[48:49], v[76:77] op_sel:[1,1,0] op_sel_hi:[0,1,1] neg_lo:[1,0,0]
  v_pk_fma_f32 v[74:75], v[70:71], v[50:51], v[78:79] op_sel:[1,1,0] op_sel_hi:[0,1,1] neg_lo:[1,0,0]
  v_pk_fma_f32 v[8:9], v[12:13], v[48:49], v[16:17] op_sel:[1,1,0] op_sel_hi:[0,1,1] neg_lo:[1,0,0]
  v_pk_fma_f32 v[10:11], v[14:15], v[50:51], v[18:19] op_sel:[1,1,0] op_sel_hi:[0,1,1] neg_lo:[1,0,0]
  v_cvt_pk_f16_f32 v84, v72, v73
  v_cvt_pk_f16_f32 v85, v74, v75
  v_cvt_pk_f16_f32 v86, v8, v9
  v_cvt_pk_f16_f32 v87, v10, v11
  ds_write2_b64 v196, v[84:85], v[86:87] offset0:132 offset1:198
  v_pk_mul_f32 v[76:77], v[72:73], v[48:49] op_sel:[0,0] op_sel_hi:[1,0]
  v_pk_mul_f32 v[78:79], v[74:75], v[50:51] op_sel:[0,0] op_sel_hi:[1,0]
  v_pk_mul_f32 v[16:17], v[8:9], v[48:49] op_sel:[0,0] op_sel_hi:[1,0]
  v_pk_mul_f32 v[18:19], v[10:11], v[50:51] op_sel:[0,0] op_sel_hi:[1,0]
  v_pk_fma_f32 v[72:73], v[72:73], v[48:49], v[76:77] op_sel:[1,1,0] op_sel_hi:[0,1,1] neg_lo:[1,0,0]
  v_pk_fma_f32 v[74:75], v[74:75], v[50:51], v[78:79] op_sel:[1,1,0] op_sel_hi:[0,1,1] neg_lo:[1,0,0]
  v_pk_fma_f32 v[8:9], v[8:9], v[48:49], v[16:17] op_sel:[1,1,0] op_sel_hi:[0,1,1] neg_lo:[1,0,0]
  v_pk_fma_f32 v[10:11], v[10:11], v[50:51], v[18:19] op_sel:[1,1,0] op_sel_hi:[0,1,1] neg_lo:[1,0,0]
  v_cvt_pk_f16_f32 v84, v72, v73
  v_cvt_pk_f16_f32 v85, v74, v75
  v_cvt_pk_f16_f32 v86, v8, v9
  v_cvt_pk_f16_f32 v87, v10, v11
  ds_write2_b64 v197, v[84:85], v[86:87] offset0:0 offset1:66
  v_pk_mul_f32 v[76:77], v[72:73], v[48:49] op_sel:[0,0] op_sel_hi:[1,0]
  v_pk_mul_f32 v[78:79], v[74:75], v[50:51] op_sel:[0,0] op_sel_hi:[1,0]
  v_pk_mul_f32 v[16:17], v[8:9], v[48:49] op_sel:[0,0] op_sel_hi:[1,0]
  v_pk_mul_f32 v[18:19], v[10:11], v[50:51] op_sel:[0,0] op_sel_hi:[1,0]
  v_pk_fma_f32 v[72:73], v[72:73], v[48:49], v[76:77] op_sel:[1,1,0] op_sel_hi:[0,1,1] neg_lo:[1,0,0]
  v_pk_fma_f32 v[74:75], v[74:75], v[50:51], v[78:79] op_sel:[1,1,0] op_sel_hi:[0,1,1] neg_lo:[1,0,0]
  v_pk_fma_f32 v[8:9], v[8:9], v[48:49], v[16:17] op_sel:[1,1,0] op_sel_hi:[0,1,1] neg_lo:[1,0,0]
  v_pk_fma_f32 v[10:11], v[10:11], v[50:51], v[18:19] op_sel:[1,1,0] op_sel_hi:[0,1,1] neg_lo:[1,0,0]
  v_cvt_pk_f16_f32 v84, v72, v73
  v_cvt_pk_f16_f32 v85, v74, v75
  v_cvt_pk_f16_f32 v86, v8, v9
  v_cvt_pk_f16_f32 v87, v10, v11
  ds_write2_b64 v197, v[84:85], v[86:87] offset0:132 offset1:198
  v_pk_mul_f32 v[76:77], v[72:73], v[48:49] op_sel:[0,0] op_sel_hi:[1,0]
  v_pk_mul_f32 v[78:79], v[74:75], v[50:51] op_sel:[0,0] op_sel_hi:[1,0]
  v_pk_mul_f32 v[16:17], v[8:9], v[48:49] op_sel:[0,0] op_sel_hi:[1,0]
  v_pk_mul_f32 v[18:19], v[10:11], v[50:51] op_sel:[0,0] op_sel_hi:[1,0]
  v_pk_fma_f32 v[72:73], v[72:73], v[48:49], v[76:77] op_sel:[1,1,0] op_sel_hi:[0,1,1] neg_lo:[1,0,0]
  v_pk_fma_f32 v[74:75], v[74:75], v[50:51], v[78:79] op_sel:[1,1,0] op_sel_hi:[0,1,1] neg_lo:[1,0,0]
  v_pk_fma_f32 v[8:9], v[8:9], v[48:49], v[16:17] op_sel:[1,1,0] op_sel_hi:[0,1,1] neg_lo:[1,0,0]
  v_pk_fma_f32 v[10:11], v[10:11], v[50:51], v[18:19] op_sel:[1,1,0] op_sel_hi:[0,1,1] neg_lo:[1,0,0]
  v_cvt_pk_f16_f32 v84, v72, v73
  v_cvt_pk_f16_f32 v85, v74, v75
  v_cvt_pk_f16_f32 v86, v8, v9
  v_cvt_pk_f16_f32 v87, v10, v11
  ds_write2_b64 v198, v[84:85], v[86:87] offset0:0 offset1:66
  v_pk_mul_f32 v[76:77], v[68:69], v[28:29] op_sel:[0,0] op_sel_hi:[1,0]
  v_pk_mul_f32 v[78:79], v[70:71], v[30:31] op_sel:[0,0] op_sel_hi:[1,0]
  v_pk_mul_f32 v[16:17], v[12:13], v[28:29] op_sel:[0,0] op_sel_hi:[1,0]
  v_pk_mul_f32 v[18:19], v[14:15], v[30:31] op_sel:[0,0] op_sel_hi:[1,0]
  v_pk_fma_f32 v[68:69], v[68:69], v[28:29], v[76:77] op_sel:[1,1,0] op_sel_hi:[0,1,1] neg_lo:[1,0,0]
  v_pk_fma_f32 v[70:71], v[70:71], v[30:31], v[78:79] op_sel:[1,1,0] op_sel_hi:[0,1,1] neg_lo:[1,0,0]
  v_pk_fma_f32 v[12:13], v[12:13], v[28:29], v[16:17] op_sel:[1,1,0] op_sel_hi:[0,1,1] neg_lo:[1,0,0]
  v_pk_fma_f32 v[14:15], v[14:15], v[30:31], v[18:19] op_sel:[1,1,0] op_sel_hi:[0,1,1] neg_lo:[1,0,0]
  s_waitcnt lgkmcnt(5)
  v_mfma_f32_16x16x32_f16 v[164:167], v[128:131], v[96:99], 0
  v_mfma_f32_16x16x32_f16 v[164:167], v[132:135], v[100:103], v[164:167]
  v_mfma_f32_16x16x32_f16 v[164:167], v[136:139], v[104:107], v[164:167]
  v_mfma_f32_16x16x32_f16 v[164:167], v[140:143], v[108:111], v[164:167]
  v_mfma_f32_16x16x32_f16 v[164:167], v[144:147], v[112:115], v[164:167]
  v_mfma_f32_16x16x32_f16 v[164:167], v[148:151], v[116:119], v[164:167]
  v_mfma_f32_16x16x32_f16 v[164:167], v[152:155], v[120:123], v[164:167]
  v_mfma_f32_16x16x32_f16 v[164:167], v[156:159], v[124:127], v[164:167]
  ds_read_b128 v[128:131], v194 offset:0
  ds_read_b128 v[132:135], v194 offset:64
  ds_read_b128 v[136:139], v194 offset:128
  ds_read_b128 v[140:143], v194 offset:192
  ds_read_b128 v[144:147], v194 offset:256
  ds_read_b128 v[148:151], v194 offset:320
  ds_read_b128 v[152:155], v194 offset:384
  ds_read_b128 v[156:159], v194 offset:448
  v_cvt_pk_f16_f32 v84, v68, v69
  v_cvt_pk_f16_f32 v85, v70, v71
  v_cvt_pk_f16_f32 v86, v12, v13
  v_cvt_pk_f16_f32 v87, v14, v15
  ds_write2_b64 v196, v[84:85], v[86:87] offset0:0 offset1:66
  v_pk_mul_f32 v[76:77], v[68:69], v[52:53] op_sel:[0,0] op_sel_hi:[1,0]
  v_pk_mul_f32 v[78:79], v[70:71], v[54:55] op_sel:[0,0] op_sel_hi:[1,0]
  v_pk_mul_f32 v[16:17], v[12:13], v[52:53] op_sel:[0,0] op_sel_hi:[1,0]
  v_pk_mul_f32 v[18:19], v[14:15], v[54:55] op_sel:[0,0] op_sel_hi:[1,0]
  v_pk_fma_f32 v[72:73], v[68:69], v[52:53], v[76:77] op_sel:[1,1,0] op_sel_hi:[0,1,1] neg_lo:[1,0,0]
  v_pk_fma_f32 v[74:75], v[70:71], v[54:55], v[78:79] op_sel:[1,1,0] op_sel_hi:[0,1,1] neg_lo:[1,0,0]
  v_pk_fma_f32 v[8:9], v[12:13], v[52:53], v[16:17] op_sel:[1,1,0] op_sel_hi:[0,1,1] neg_lo:[1,0,0]
  v_pk_fma_f32 v[10:11], v[14:15], v[54:55], v[18:19] op_sel:[1,1,0] op_sel_hi:[0,1,1] neg_lo:[1,0,0]
  v_cvt_pk_f16_f32 v84, v72, v73
  v_cvt_pk_f16_f32 v85, v74, v75
  v_cvt_pk_f16_f32 v86, v8, v9
  v_cvt_pk_f16_f32 v87, v10, v11
  ds_write2_b64 v196, v[84:85], v[86:87] offset0:132 offset1:198
  v_pk_mul_f32 v[76:77], v[72:73], v[52:53] op_sel:[0,0] op_sel_hi:[1,0]
  v_pk_mul_f32 v[78:79], v[74:75], v[54:55] op_sel:[0,0] op_sel_hi:[1,0]
  v_pk_mul_f32 v[16:17], v[8:9], v[52:53] op_sel:[0,0] op_sel_hi:[1,0]
  v_pk_mul_f32 v[18:19], v[10:11], v[54:55] op_sel:[0,0] op_sel_hi:[1,0]
  v_pk_fma_f32 v[72:73], v[72:73], v[52:53], v[76:77] op_sel:[1,1,0] op_sel_hi:[0,1,1] neg_lo:[1,0,0]
  v_pk_fma_f32 v[74:75], v[74:75], v[54:55], v[78:79] op_sel:[1,1,0] op_sel_hi:[0,1,1] neg_lo:[1,0,0]
  v_pk_fma_f32 v[8:9], v[8:9], v[52:53], v[16:17] op_sel:[1,1,0] op_sel_hi:[0,1,1] neg_lo:[1,0,0]
  v_pk_fma_f32 v[10:11], v[10:11], v[54:55], v[18:19] op_sel:[1,1,0] op_sel_hi:[0,1,1] neg_lo:[1,0,0]
  v_cvt_pk_f16_f32 v84, v72, v73
  v_cvt_pk_f16_f32 v85, v74, v75
  v_cvt_pk_f16_f32 v86, v8, v9
  v_cvt_pk_f16_f32 v87, v10, v11
  ds_write2_b64 v197, v[84:85], v[86:87] offset0:0 offset1:66
  v_pk_mul_f32 v[76:77], v[68:69], v[28:29] op_sel:[0,0] op_sel_hi:[1,0]
  v_pk_mul_f32 v[78:79], v[70:71], v[30:31] op_sel:[0,0] op_sel_hi:[1,0]
  v_pk_mul_f32 v[16:17], v[12:13], v[28:29] op_sel:[0,0] op_sel_hi:[1,0]
  v_pk_mul_f32 v[18:19], v[14:15], v[30:31] op_sel:[0,0] op_sel_hi:[1,0]
  v_pk_fma_f32 v[68:69], v[68:69], v[28:29], v[76:77] op_sel:[1,1,0] op_sel_hi:[0,1,1] neg_lo:[1,0,0]
  v_pk_fma_f32 v[70:71], v[70:71], v[30:31], v[78:79] op_sel:[1,1,0] op_sel_hi:[0,1,1] neg_lo:[1,0,0]
  v_pk_fma_f32 v[12:13], v[12:13], v[28:29], v[16:17] op_sel:[1,1,0] op_sel_hi:[0,1,1] neg_lo:[1,0,0]
  v_pk_fma_f32 v[14:15], v[14:15], v[30:31], v[18:19] op_sel:[1,1,0] op_sel_hi:[0,1,1] neg_lo:[1,0,0]
  v_cvt_pk_f16_f32 v84, v68, v69
  v_cvt_pk_f16_f32 v85, v70, v71
  v_cvt_pk_f16_f32 v86, v12, v13
  v_cvt_pk_f16_f32 v87, v14, v15
  ds_write2_b64 v197, v[84:85], v[86:87] offset0:132 offset1:198
  v_pk_mul_f32 v[76:77], v[68:69], v[52:53] op_sel:[0,0] op_sel_hi:[1,0]
  v_pk_mul_f32 v[78:79], v[70:71], v[54:55] op_sel:[0,0] op_sel_hi:[1,0]
  v_pk_mul_f32 v[16:17], v[12:13], v[52:53] op_sel:[0,0] op_sel_hi:[1,0]
  v_pk_mul_f32 v[18:19], v[14:15], v[54:55] op_sel:[0,0] op_sel_hi:[1,0]
  v_pk_fma_f32 v[72:73], v[68:69], v[52:53], v[76:77] op_sel:[1,1,0] op_sel_hi:[0,1,1] neg_lo:[1,0,0]
  v_pk_fma_f32 v[74:75], v[70:71], v[54:55], v[78:79] op_sel:[1,1,0] op_sel_hi:[0,1,1] neg_lo:[1,0,0]
  v_pk_fma_f32 v[8:9], v[12:13], v[52:53], v[16:17] op_sel:[1,1,0] op_sel_hi:[0,1,1] neg_lo:[1,0,0]
  v_pk_fma_f32 v[10:11], v[14:15], v[54:55], v[18:19] op_sel:[1,1,0] op_sel_hi:[0,1,1] neg_lo:[1,0,0]
  v_cvt_pk_f16_f32 v84, v72, v73
  v_cvt_pk_f16_f32 v85, v74, v75
  v_cvt_pk_f16_f32 v86, v8, v9
  v_cvt_pk_f16_f32 v87, v10, v11
  ds_write2_b64 v198, v[84:85], v[86:87] offset0:0 offset1:66
  v_pk_mul_f32 v[76:77], v[72:73], v[52:53] op_sel:[0,0] op_sel_hi:[1,0]
  v_pk_mul_f32 v[78:79], v[74:75], v[54:55] op_sel:[0,0] op_sel_hi:[1,0]
  v_pk_mul_f32 v[16:17], v[8:9], v[52:53] op_sel:[0,0] op_sel_hi:[1,0]
  v_pk_mul_f32 v[18:19], v[10:11], v[54:55] op_sel:[0,0] op_sel_hi:[1,0]
  v_pk_fma_f32 v[72:73], v[72:73], v[52:53], v[76:77] op_sel:[1,1,0] op_sel_hi:[0,1,1] neg_lo:[1,0,0]
  v_pk_fma_f32 v[74:75], v[74:75], v[54:55], v[78:79] op_sel:[1,1,0] op_sel_hi:[0,1,1] neg_lo:[1,0,0]
  v_pk_fma_f32 v[8:9], v[8:9], v[52:53], v[16:17] op_sel:[1,1,0] op_sel_hi:[0,1,1] neg_lo:[1,0,0]
  v_pk_fma_f32 v[10:11], v[10:11], v[54:55], v[18:19] op_sel:[1,1,0] op_sel_hi:[0,1,1] neg_lo:[1,0,0]
  v_cvt_pk_f16_f32 v84, v72, v73
  v_cvt_pk_f16_f32 v85, v74, v75
  v_cvt_pk_f16_f32 v86, v8, v9
  v_cvt_pk_f16_f32 v87, v10, v11
  ds_write2_b64 v198, v[84:85], v[86:87] offset0:132 offset1:198
  s_waitcnt lgkmcnt(6)
  v_mfma_f32_16x16x32_f16 v[168:171], v[128:131], v[96:99], 0
  v_mfma_f32_16x16x32_f16 v[168:171], v[132:135], v[100:103], v[168:171]
  v_mfma_f32_16x16x32_f16 v[168:171], v[136:139], v[104:107], v[168:171]
  v_mfma_f32_16x16x32_f16 v[168:171], v[140:143], v[108:111], v[168:171]
  v_mfma_f32_16x16x32_f16 v[168:171], v[144:147], v[112:115], v[168:171]
  v_mfma_f32_16x16x32_f16 v[168:171], v[148:151], v[116:119], v[168:171]
  v_mfma_f32_16x16x32_f16 v[168:171], v[152:155], v[120:123], v[168:171]
  v_mfma_f32_16x16x32_f16 v[168:171], v[156:159], v[124:127], v[168:171]
  ds_read_b128 v[128:131], v195 offset:0
  ds_read_b128 v[132:135], v195 offset:64
  ds_read_b128 v[136:139], v195 offset:128
  ds_read_b128 v[140:143], v195 offset:192
  ds_read_b128 v[144:147], v195 offset:256
  ds_read_b128 v[148:151], v195 offset:320
  ds_read_b128 v[152:155], v195 offset:384
  ds_read_b128 v[156:159], v195 offset:448
  ds_write_b32 v200, v205
  v_lshlrev_b32 v90, 16, v39
  v_cmp_eq_u32 vcc, 0, v0
  s_nop 1
  v_cndmask_b32 v90, 0, v90, vcc
  v_mul_f32 v160, v160, v95
  v_mul_f32 v161, v161, v95
  v_mul_f32 v162, v162, v95
  v_mul_f32 v163, v163, v95
  v_mul_f32 v164, v164, v95
  v_mul_f32 v165, v165, v95
  v_mul_f32 v166, v166, v95
  v_mul_f32 v167, v167, v95
  v_mul_f32 v168, v168, v95
  v_mul_f32 v169, v169, v95
  v_mul_f32 v170, v170, v95
  v_mul_f32 v171, v171, v95
  v_add_f32 v160, v160, v90
  v_cvt_pk_bf16_f32 v56, v168, v168
  v_cvt_pk_bf16_f32 v57, v168, v169
  v_cvt_pk_bf16_f32 v58, v169, v169
  v_cvt_pk_bf16_f32 v59, v170, v170
  v_cvt_pk_bf16_f32 v60, v168, v168
  v_cvt_pk_bf16_f32 v61, v168, v168
  v_cvt_pk_bf16_f32 v62, v168, v169
  v_cvt_pk_bf16_f32 v63, v169, v169
  s_waitcnt lgkmcnt(1)
  v_mfma_f32_16x16x32_f16 v[172:175], v[128:131], v[96:99], 0
  v_mfma_f32_16x16x32_f16 v[172:175], v[132:135], v[100:103], v[172:175]
  v_mfma_f32_16x16x32_f16 v[172:175], v[136:139], v[104:107], v[172:175]
  v_mfma_f32_16x16x32_f16 v[172:175], v[140:143], v[108:111], v[172:175]
  v_mfma_f32_16x16x32_f16 v[172:175], v[144:147], v[112:115], v[172:175]
  v_mfma_f32_16x16x32_f16 v[172:175], v[148:151], v[116:119], v[172:175]
  v_mfma_f32_16x16x32_f16 v[172:175], v[152:155], v[120:123], v[172:175]
  v_mfma_f32_16x16x32_f16 v[172:175], v[156:159], v[124:127], v[172:175]
  ds_write_b128 v201, v[56:59] offset:1136
  ds_write_b128 v201, v[60:63] offset:5616
  v_cvt_pk_bf16_f32 v64, v164, v164
  v_cvt_pk_bf16_f32 v65, v165, v166
  v_cvt_pk_bf16_f32 v66, v160, v161
  v_cvt_pk_bf16_f32 v67, v162, v163
  ds_write_b64 v202, v[64:65] offset:624
  ds_write2_b32 v203, v64, v65 offset0:157 offset1:158
  ds_write_b64 v202, v[66:67] offset:112
  ds_write2_b32 v203, v66, v67 offset0:29 offset1:30
  v_mul_f32 v172, v172, v95
  v_mul_f32 v173, v173, v95
  v_mul_f32 v174, v174, v95
  v_cvt_pk_bf16_f32 v40, v172, v172
  v_cvt_pk_bf16_f32 v41, v172, v172
  v_cvt_pk_bf16_f32 v42, v172, v173
  v_cvt_pk_bf16_f32 v43, v173, v173
  v_cvt_pk_bf16_f32 v44, v173, v173
  v_cvt_pk_bf16_f32 v45, v173, v173
  v_cvt_pk_bf16_f32 v46, v174, v174
  v_cvt_pk_bf16_f32 v47, v174, v174
  v_cvt_pk_bf16_f32 v48, v172, v172
  v_cvt_pk_bf16_f32 v49, v172, v172
  v_cvt_pk_bf16_f32 v50, v172, v172
  v_cvt_pk_bf16_f32 v51, v172, v173
  v_cvt_pk_bf16_f32 v52, v173, v173
  v_cvt_pk_bf16_f32 v53, v173, v173
  v_cvt_pk_bf16_f32 v54, v173, v173
  v_cvt_pk_bf16_f32 v55, v174, v174
  ds_write_b128 v204, v[40:43] offset:2160
  ds_write_b128 v204, v[44:47] offset:2176
  ds_write_b128 v204, v[48:51] offset:6640
  ds_write_b128 v204, v[52:55] offset:6656
  s_waitcnt lgkmcnt(0)
  s_barrier
  ds_read_b128 v[104:107], v186 offset:0
  ds_read_b64_tr_b16 v[120:121], v190 offset:0
  ds_read_b64_tr_b16 v[122:123], v190 offset:512
  ds_read_b128 v[108:111], v186 offset:2048
  ds_read_b128 v[112:115], v186 offset:4096
  ds_read_b128 v[116:119], v186 offset:6144
  ds_read_b64_tr_b16 v[124:125], v191 offset:0
  ds_read_b64_tr_b16 v[126:127], v191 offset:512
  ds_read_b64_tr_b16 v[128:129], v190 offset:8192
  ds_read_b64_tr_b16 v[130:131], v190 offset:8704
  ds_read_b64_tr_b16 v[132:133], v191 offset:8192
  ds_read_b64_tr_b16 v[134:135], v191 offset:8704
  ds_read_b64_tr_b16 v[136:137], v190 offset:16384
  ds_read_b64_tr_b16 v[138:139], v190 offset:16896
  ds_read_b64_tr_b16 v[140:141], v191 offset:16384
  ds_read_b64_tr_b16 v[142:143], v191 offset:16896
  s_waitcnt lgkmcnt(0)
  v_mfma_f32_16x16x32_bf16 v[8:11], v[120:123], v[104:107], 0
  ds_read_b128 v[144:147], v187 offset:0
  v_mfma_f32_16x16x32_bf16 v[12:15], v[120:123], v[108:111], 0
  ds_read_b64_tr_b16 v[160:161], v190 offset:4096
  v_mfma_f32_16x16x32_bf16 v[16:19], v[120:123], v[112:115], 0
  ds_read_b64_tr_b16 v[162:163], v190 offset:4608
  v_mfma_f32_16x16x32_bf16 v[20:23], v[120:123], v[116:119], 0
  ds_read_b128 v[148:151], v187 offset:2048
  v_mfma_f32_16x16x32_bf16 v[36:39], v[124:127], v[116:119], 0
  ds_read_b128 v[152:155], v187 offset:4096
  v_mfma_f32_16x16x32_bf16 v[32:35], v[124:127], v[112:115], 0
  ds_read_b128 v[156:159], v187 offset:6144
  v_mfma_f32_16x16x32_bf16 v[28:31], v[124:127], v[108:111], 0
  ds_read_b64_tr_b16 v[164:165], v191 offset:4096
  v_mfma_f32_16x16x32_bf16 v[24:27], v[124:127], v[104:107], 0
  ds_read_b64_tr_b16 v[166:167], v191 offset:4608
  v_mfma_f32_16x16x32_bf16 v[40:43], v[104:107], v[128:131], 0
  ds_read_b64_tr_b16 v[168:169], v190 offset:12288
  v_mfma_f32_16x16x32_bf16 v[44:47], v[108:111], v[128:131], 0
  ds_read_b64_tr_b16 v[170:171], v190 offset:12800
  v_mfma_f32_16x16x32_bf16 v[48:51], v[112:115], v[128:131], 0
  ds_read_b64_tr_b16 v[172:173], v191 offset:12288
  v_mfma_f32_16x16x32_bf16 v[52:55], v[116:119], v[128:131], 0
  ds_read_b64_tr_b16 v[174:175], v191 offset:12800
  v_mfma_f32_16x16x32_bf16 v[68:71], v[116:119], v[132:135], 0
  ds_read_b64_tr_b16 v[176:177], v190 offset:20480
  v_mfma_f32_16x16x32_bf16 v[64:67], v[112:115], v[132:135], 0
  ds_read_b64_tr_b16 v[178:179], v190 offset:20992
  v_mfma_f32_16x16x32_bf16 v[60:63], v[108:111], v[132:135], 0
  ds_read_b64_tr_b16 v[180:181], v191 offset:20480
  v_mfma_f32_16x16x32_bf16 v[56:59], v[104:107], v[132:135], 0
  ds_read_b64_tr_b16 v[182:183], v191 offset:20992
  v_mfma_f32_16x16x32_bf16 v[72:75], v[104:107], v[136:139], 0
  v_mfma_f32_16x16x32_bf16 v[76:79], v[108:111], v[136:139], 0
  v_mfma_f32_16x16x32_bf16 v[80:83], v[112:115], v[136:139], 0
  v_mfma_f32_16x16x32_bf16 v[84:87], v[116:119], v[136:139], 0
  v_mfma_f32_16x16x32_bf16 v[100:103], v[116:119], v[140:143], 0
  v_mfma_f32_16x16x32_bf16 v[96:99], v[112:115], v[140:143], 0
  v_mfma_f32_16x16x32_bf16 v[92:95], v[108:111], v[140:143], 0
  v_mfma_f32_16x16x32_bf16 v[88:91], v[104:107], v[140:143], 0
  s_waitcnt lgkmcnt(0)
  s_barrier
  v_mfma_f32_16x16x32_bf16 v[8:11], v[160:163], v[144:147], v[8:11]
  ds_read_b128 v[104:107], v184 offset:0
  v_mfma_f32_16x16x32_bf16 v[12:15], v[160:163], v[148:151], v[12:15]
  ds_read_b64_tr_b16 v[120:121], v188 offset:0
  v_mfma_f32_16x16x32_bf16 v[16:19], v[160:163], v[152:155], v[16:19]
  ds_read_b64_tr_b16 v[122:123], v188 offset:512
  v_mfma_f32_16x16x32_bf16 v[20:23], v[160:163], v[156:159], v[20:23]
  ds_read_b128 v[108:111], v184 offset:2048
  v_mfma_f32_16x16x32_bf16 v[36:39], v[164:167], v[156:159], v[36:39]
  ds_read_b128 v[112:115], v184 offset:4096
  v_mfma_f32_16x16x32_bf16 v[32:35], v[164:167], v[152:155], v[32:35]
  ds_read_b128 v[116:119], v184 offset:6144
  v_mfma_f32_16x16x32_bf16 v[28:31], v[164:167], v[148:151], v[28:31]
  ds_read_b64_tr_b16 v[124:125], v189 offset:0
  v_mfma_f32_16x16x32_bf16 v[24:27], v[164:167], v[144:147], v[24:27]
  ds_read_b64_tr_b16 v[126:127], v189 offset:512
  v_mfma_f32_16x16x32_bf16 v[40:43], v[144:147], v[168:171], v[40:43]
  ds_read_b64_tr_b16 v[128:129], v188 offset:8192
  v_mfma_f32_16x16x32_bf16 v[44:47], v[148:151], v[168:171], v[44:47]
  ds_read_b64_tr_b16 v[130:131], v188 offset:8704
  v_mfma_f32_16x16x32_bf16 v[48:51], v[152:155], v[168:171], v[48:51]
  ds_read_b64_tr_b16 v[132:133], v189 offset:8192
  v_mfma_f32_16x16x32_bf16 v[52:55], v[156:159], v[168:171], v[52:55]
  ds_read_b64_tr_b16 v[134:135], v189 offset:8704
  v_mfma_f32_16x16x32_bf16 v[68:71], v[156:159], v[172:175], v[68:71]
  ds_read_b64_tr_b16 v[136:137], v188 offset:16384
  v_mfma_f32_16x16x32_bf16 v[64:67], v[152:155], v[172:175], v[64:67]
  ds_read_b64_tr_b16 v[138:139], v188 offset:16896
  v_mfma_f32_16x16x32_bf16 v[60:63], v[148:151], v[172:175], v[60:63]
  ds_read_b64_tr_b16 v[140:141], v189 offset:16384
  v_mfma_f32_16x16x32_bf16 v[56:59], v[144:147], v[172:175], v[56:59]
  ds_read_b64_tr_b16 v[142:143], v189 offset:16896
  v_mfma_f32_16x16x32_bf16 v[72:75], v[144:147], v[176:179], v[72:75]
  v_mfma_f32_16x16x32_bf16 v[76:79], v[148:151], v[176:179], v[76:79]
  v_mfma_f32_16x16x32_bf16 v[80:83], v[152:155], v[176:179], v[80:83]
  v_mfma_f32_16x16x32_bf16 v[84:87], v[156:159], v[176:179], v[84:87]
  v_mfma_f32_16x16x32_bf16 v[100:103], v[156:159], v[180:183], v[100:103]
  v_mfma_f32_16x16x32_bf16 v[96:99], v[152:155], v[180:183], v[96:99]
  v_mfma_f32_16x16x32_bf16 v[92:95], v[148:151], v[180:183], v[92:95]
  v_mfma_f32_16x16x32_bf16 v[88:91], v[144:147], v[180:183], v[88:91]
  s_waitcnt lgkmcnt(0)
  v_mfma_f32_16x16x32_bf16 v[8:11], v[120:123], v[104:107], v[8:11]
  ds_read_b128 v[144:147], v185 offset:0
  v_mfma_f32_16x16x32_bf16 v[12:15], v[120:123], v[108:111], v[12:15]
  ds_read_b64_tr_b16 v[160:161], v188 offset:4096
  v_mfma_f32_16x16x32_bf16 v[16:19], v[120:123], v[112:115], v[16:19]
  ds_read_b64_tr_b16 v[162:163], v188 offset:4608
  v_mfma_f32_16x16x32_bf16 v[20:23], v[120:123], v[116:119], v[20:23]
  ds_read_b128 v[148:151], v185 offset:2048
  v_mfma_f32_16x16x32_bf16 v[36:39], v[124:127], v[116:119], v[36:39]
  ds_read_b128 v[152:155], v185 offset:4096
  v_mfma_f32_16x16x32_bf16 v[32:35], v[124:127], v[112:115], v[32:35]
  ds_read_b128 v[156:159], v185 offset:6144
  v_mfma_f32_16x16x32_bf16 v[28:31], v[124:127], v[108:111], v[28:31]
  ds_read_b64_tr_b16 v[164:165], v189 offset:4096
  v_mfma_f32_16x16x32_bf16 v[24:27], v[124:127], v[104:107], v[24:27]
  ds_read_b64_tr_b16 v[166:167], v189 offset:4608
  v_mfma_f32_16x16x32_bf16 v[40:43], v[104:107], v[128:131], v[40:43]
  ds_read_b64_tr_b16 v[168:169], v188 offset:12288
  v_mfma_f32_16x16x32_bf16 v[44:47], v[108:111], v[128:131], v[44:47]
  ds_read_b64_tr_b16 v[170:171], v188 offset:12800
  v_mfma_f32_16x16x32_bf16 v[48:51], v[112:115], v[128:131], v[48:51]
  ds_read_b64_tr_b16 v[172:173], v189 offset:12288
  v_mfma_f32_16x16x32_bf16 v[52:55], v[116:119], v[128:131], v[52:55]
  ds_read_b64_tr_b16 v[174:175], v189 offset:12800
  v_mfma_f32_16x16x32_bf16 v[68:71], v[116:119], v[132:135], v[68:71]
  ds_read_b64_tr_b16 v[176:177], v188 offset:20480
  v_mfma_f32_16x16x32_bf16 v[64:67], v[112:115], v[132:135], v[64:67]
  ds_read_b64_tr_b16 v[178:179], v188 offset:20992
  v_mfma_f32_16x16x32_bf16 v[60:63], v[108:111], v[132:135], v[60:63]
  ds_read_b64_tr_b16 v[180:181], v189 offset:20480
  v_mfma_f32_16x16x32_bf16 v[56:59], v[104:107], v[132:135], v[56:59]
  ds_read_b64_tr_b16 v[182:183], v189 offset:20992
  v_mfma_f32_16x16x32_bf16 v[72:75], v[104:107], v[136:139], v[72:75]
  v_mfma_f32_16x16x32_bf16 v[76:79], v[108:111], v[136:139], v[76:79]
  v_mfma_f32_16x16x32_bf16 v[80:83], v[112:115], v[136:139], v[80:83]
  v_mfma_f32_16x16x32_bf16 v[84:87], v[116:119], v[136:139], v[84:87]
  v_mfma_f32_16x16x32_bf16 v[100:103], v[116:119], v[140:143], v[100:103]
  v_mfma_f32_16x16x32_bf16 v[96:99], v[112:115], v[140:143], v[96:99]
  v_mfma_f32_16x16x32_bf16 v[92:95], v[108:111], v[140:143], v[92:95]
  v_mfma_f32_16x16x32_bf16 v[88:91], v[104:107], v[140:143], v[88:91]
  s_waitcnt lgkmcnt(0)
  s_barrier
  v_mfma_f32_16x16x32_bf16 v[8:11], v[160:163], v[144:147], v[8:11]
  ds_read_b128 v[104:107], v184 offset:40960
  v_mfma_f32_16x16x32_bf16 v[12:15], v[160:163], v[148:151], v[12:15]
  ds_read_b64_tr_b16 v[120:121], v188 offset:40960
  v_mfma_f32_16x16x32_bf16 v[16:19], v[160:163], v[152:155], v[16:19]
  ds_read_b64_tr_b16 v[122:123], v188 offset:41472
  v_mfma_f32_16x16x32_bf16 v[20:23], v[160:163], v[156:159], v[20:23]
  ds_read_b128 v[108:111], v184 offset:43008
  v_mfma_f32_16x16x32_bf16 v[36:39], v[164:167], v[156:159], v[36:39]
  ds_read_b128 v[112:115], v184 offset:45056
  v_mfma_f32_16x16x32_bf16 v[32:35], v[164:167], v[152:155], v[32:35]
  ds_read_b128 v[116:119], v184 offset:47104
  v_mfma_f32_16x16x32_bf16 v[28:31], v[164:167], v[148:151], v[28:31]
  ds_read_b64_tr_b16 v[124:125], v189 offset:40960
  v_mfma_f32_16x16x32_bf16 v[24:27], v[164:167], v[144:147], v[24:27]
  ds_read_b64_tr_b16 v[126:127], v189 offset:41472
  v_mfma_f32_16x16x32_bf16 v[40:43], v[144:147], v[168:171], v[40:43]
  ds_read_b64_tr_b16 v[128:129], v188 offset:49152
  v_mfma_f32_16x16x32_bf16 v[44:47], v[148:151], v[168:171], v[44:47]
  ds_read_b64_tr_b16 v[130:131], v188 offset:49664
  v_mfma_f32_16x16x32_bf16 v[48:51], v[152:155], v[168:171], v[48:51]
  ds_read_b64_tr_b16 v[132:133], v189 offset:49152
  v_mfma_f32_16x16x32_bf16 v[52:55], v[156:159], v[168:171], v[52:55]
  ds_read_b64_tr_b16 v[134:135], v189 offset:49664
  v_mfma_f32_16x16x32_bf16 v[68:71], v[156:159], v[172:175], v[68:71]
  ds_read_b64_tr_b16 v[136:137], v188 offset:57344
  v_mfma_f32_16x16x32_bf16 v[64:67], v[152:155], v[172:175], v[64:67]
  ds_read_b64_tr_b16 v[138:139], v188 offset:57856
  v_mfma_f32_16x16x32_bf16 v[60:63], v[148:151], v[172:175], v[60:63]
  ds_read_b64_tr_b16 v[140:141], v189 offset:57344
  v_mfma_f32_16x16x32_bf16 v[56:59], v[144:147], v[172:175], v[56:59]
  ds_read_b64_tr_b16 v[142:143], v189 offset:57856
  v_mfma_f32_16x16x32_bf16 v[72:75], v[144:147], v[176:179], v[72:75]
  v_mfma_f32_16x16x32_bf16 v[76:79], v[148:151], v[176:179], v[76:79]
  v_mfma_f32_16x16x32_bf16 v[80:83], v[152:155], v[176:179], v[80:83]
  v_mfma_f32_16x16x32_bf16 v[84:87], v[156:159], v[176:179], v[84:87]
  v_mfma_f32_16x16x32_bf16 v[100:103], v[156:159], v[180:183], v[100:103]
  v_mfma_f32_16x16x32_bf16 v[96:99], v[152:155], v[180:183], v[96:99]
  v_mfma_f32_16x16x32_bf16 v[92:95], v[148:151], v[180:183], v[92:95]
  v_mfma_f32_16x16x32_bf16 v[88:91], v[144:147], v[180:183], v[88:91]
  s_waitcnt lgkmcnt(0)
  v_mfma_f32_16x16x32_bf16 v[8:11], v[120:123], v[104:107], v[8:11]
  ds_read_b128 v[144:147], v185 offset:40960
  v_mfma_f32_16x16x32_bf16 v[12:15], v[120:123], v[108:111], v[12:15]
  ds_read_b64_tr_b16 v[160:161], v188 offset:45056
  v_mfma_f32_16x16x32_bf16 v[16:19], v[120:123], v[112:115], v[16:19]
  ds_read_b64_tr_b16 v[162:163], v188 offset:45568
  v_mfma_f32_16x16x32_bf16 v[20:23], v[120:123], v[116:119], v[20:23]
  ds_read_b128 v[148:151], v185 offset:43008
  v_mfma_f32_16x16x32_bf16 v[36:39], v[124:127], v[116:119], v[36:39]
  ds_read_b128 v[152:155], v185 offset:45056
  v_mfma_f32_16x16x32_bf16 v[32:35], v[124:127], v[112:115], v[32:35]
  ds_read_b128 v[156:159], v185 offset:47104
  v_mfma_f32_16x16x32_bf16 v[28:31], v[124:127], v[108:111], v[28:31]
  ds_read_b64_tr_b16 v[164:165], v189 offset:45056
  v_mfma_f32_16x16x32_bf16 v[24:27], v[124:127], v[104:107], v[24:27]
  ds_read_b64_tr_b16 v[166:167], v189 offset:45568
  v_mfma_f32_16x16x32_bf16 v[40:43], v[104:107], v[128:131], v[40:43]
  ds_read_b64_tr_b16 v[168:169], v188 offset:53248
  v_mfma_f32_16x16x32_bf16 v[44:47], v[108:111], v[128:131], v[44:47]
  ds_read_b64_tr_b16 v[170:171], v188 offset:53760
  v_mfma_f32_16x16x32_bf16 v[48:51], v[112:115], v[128:131], v[48:51]
  ds_read_b64_tr_b16 v[172:173], v189 offset:53248
  v_mfma_f32_16x16x32_bf16 v[52:55], v[116:119], v[128:131], v[52:55]
  ds_read_b64_tr_b16 v[174:175], v189 offset:53760
  v_mfma_f32_16x16x32_bf16 v[68:71], v[116:119], v[132:135], v[68:71]
  ds_read_b64_tr_b16 v[176:177], v188 offset:61440
  v_mfma_f32_16x16x32_bf16 v[64:67], v[112:115], v[132:135], v[64:67]
  ds_read_b64_tr_b16 v[178:179], v188 offset:61952
  v_mfma_f32_16x16x32_bf16 v[60:63], v[108:111], v[132:135], v[60:63]
  ds_read_b64_tr_b16 v[180:181], v189 offset:61440
  v_mfma_f32_16x16x32_bf16 v[56:59], v[104:107], v[132:135], v[56:59]
  ds_read_b64_tr_b16 v[182:183], v189 offset:61952
  v_mfma_f32_16x16x32_bf16 v[72:75], v[104:107], v[136:139], v[72:75]
  v_mfma_f32_16x16x32_bf16 v[76:79], v[108:111], v[136:139], v[76:79]
  v_mfma_f32_16x16x32_bf16 v[80:83], v[112:115], v[136:139], v[80:83]
  v_mfma_f32_16x16x32_bf16 v[84:87], v[116:119], v[136:139], v[84:87]
  v_mfma_f32_16x16x32_bf16 v[100:103], v[116:119], v[140:143], v[100:103]
  v_mfma_f32_16x16x32_bf16 v[96:99], v[112:115], v[140:143], v[96:99]
  v_mfma_f32_16x16x32_bf16 v[92:95], v[108:111], v[140:143], v[92:95]
  v_mfma_f32_16x16x32_bf16 v[88:91], v[104:107], v[140:143], v[88:91]
  s_waitcnt lgkmcnt(0)
  s_barrier
  v_mfma_f32_16x16x32_bf16 v[8:11], v[160:163], v[144:147], v[8:11]
  ds_read_b128 v[104:107], v186 offset:0
  v_mfma_f32_16x16x32_bf16 v[12:15], v[160:163], v[148:151], v[12:15]
  ds_read_b64_tr_b16 v[120:121], v190 offset:0
  v_mfma_f32_16x16x32_bf16 v[16:19], v[160:163], v[152:155], v[16:19]
  ds_read_b64_tr_b16 v[122:123], v190 offset:512
  v_mfma_f32_16x16x32_bf16 v[20:23], v[160:163], v[156:159], v[20:23]
  ds_read_b128 v[108:111], v186 offset:2048
  v_mfma_f32_16x16x32_bf16 v[36:39], v[164:167], v[156:159], v[36:39]
  ds_read_b128 v[112:115], v186 offset:4096
  v_mfma_f32_16x16x32_bf16 v[32:35], v[164:167], v[152:155], v[32:35]
  ds_read_b128 v[116:119], v186 offset:6144
  v_mfma_f32_16x16x32_bf16 v[28:31], v[164:167], v[148:151], v[28:31]
  ds_read_b64_tr_b16 v[124:125], v191 offset:0
  v_mfma_f32_16x16x32_bf16 v[24:27], v[164:167], v[144:147], v[24:27]
  ds_read_b64_tr_b16 v[126:127], v191 offset:512
  v_mfma_f32_16x16x32_bf16 v[40:43], v[144:147], v[168:171], v[40:43]
  ds_read_b64_tr_b16 v[128:129], v190 offset:8192
  v_mfma_f32_16x16x32_bf16 v[44:47], v[148:151], v[168:171], v[44:47]
  ds_read_b64_tr_b16 v[130:131], v190 offset:8704
  v_mfma_f32_16x16x32_bf16 v[48:51], v[152:155], v[168:171], v[48:51]
  ds_read_b64_tr_b16 v[132:133], v191 offset:8192
  v_mfma_f32_16x16x32_bf16 v[52:55], v[156:159], v[168:171], v[52:55]
  ds_read_b64_tr_b16 v[134:135], v191 offset:8704
  v_mfma_f32_16x16x32_bf16 v[68:71], v[156:159], v[172:175], v[68:71]
  ds_read_b64_tr_b16 v[136:137], v190 offset:16384
  v_mfma_f32_16x16x32_bf16 v[64:67], v[152:155], v[172:175], v[64:67]
  ds_read_b64_tr_b16 v[138:139], v190 offset:16896
  v_mfma_f32_16x16x32_bf16 v[60:63], v[148:151], v[172:175], v[60:63]
  ds_read_b64_tr_b16 v[140:141], v191 offset:16384
  v_mfma_f32_16x16x32_bf16 v[56:59], v[144:147], v[172:175], v[56:59]
  ds_read_b64_tr_b16 v[142:143], v191 offset:16896
  v_mfma_f32_16x16x32_bf16 v[72:75], v[144:147], v[176:179], v[72:75]
  v_mfma_f32_16x16x32_bf16 v[76:79], v[148:151], v[176:179], v[76:79]
  v_mfma_f32_16x16x32_bf16 v[80:83], v[152:155], v[176:179], v[80:83]
  v_mfma_f32_16x16x32_bf16 v[84:87], v[156:159], v[176:179], v[84:87]
  v_mfma_f32_16x16x32_bf16 v[100:103], v[156:159], v[180:183], v[100:103]
  v_mfma_f32_16x16x32_bf16 v[96:99], v[152:155], v[180:183], v[96:99]
  v_mfma_f32_16x16x32_bf16 v[92:95], v[148:151], v[180:183], v[92:95]
  v_mfma_f32_16x16x32_bf16 v[88:91], v[144:147], v[180:183], v[88:91]
  s_waitcnt lgkmcnt(0)
  v_mfma_f32_16x16x32_bf16 v[8:11], v[120:123], v[104:107], v[8:11]
  ds_read_b128 v[144:147], v187 offset:0
  v_mfma_f32_16x16x32_bf16 v[12:15], v[120:123], v[108:111], v[12:15]
  ds_read_b64_tr_b16 v[160:161], v190 offset:4096
  v_mfma_f32_16x16x32_bf16 v[16:19], v[120:123], v[112:115], v[16:19]
  ds_read_b64_tr_b16 v[162:163], v190 offset:4608
  v_mfma_f32_16x16x32_bf16 v[20:23], v[120:123], v[116:119], v[20:23]
  ds_read_b128 v[148:151], v187 offset:2048
  v_mfma_f32_16x16x32_bf16 v[36:39], v[124:127], v[116:119], v[36:39]
  ds_read_b128 v[152:155], v187 offset:4096
  v_mfma_f32_16x16x32_bf16 v[32:35], v[124:127], v[112:115], v[32:35]
  ds_read_b128 v[156:159], v187 offset:6144
  v_mfma_f32_16x16x32_bf16 v[28:31], v[124:127], v[108:111], v[28:31]
  ds_read_b64_tr_b16 v[164:165], v191 offset:4096
  v_mfma_f32_16x16x32_bf16 v[24:27], v[124:127], v[104:107], v[24:27]
  ds_read_b64_tr_b16 v[166:167], v191 offset:4608
  v_mfma_f32_16x16x32_bf16 v[40:43], v[104:107], v[128:131], v[40:43]
  ds_read_b64_tr_b16 v[168:169], v190 offset:12288
  v_mfma_f32_16x16x32_bf16 v[44:47], v[108:111], v[128:131], v[44:47]
  ds_read_b64_tr_b16 v[170:171], v190 offset:12800
  v_mfma_f32_16x16x32_bf16 v[48:51], v[112:115], v[128:131], v[48:51]
  ds_read_b64_tr_b16 v[172:173], v191 offset:12288
  v_mfma_f32_16x16x32_bf16 v[52:55], v[116:119], v[128:131], v[52:55]
  ds_read_b64_tr_b16 v[174:175], v191 offset:12800
  v_mfma_f32_16x16x32_bf16 v[68:71], v[116:119], v[132:135], v[68:71]
  ds_read_b64_tr_b16 v[176:177], v190 offset:20480
  v_mfma_f32_16x16x32_bf16 v[64:67], v[112:115], v[132:135], v[64:67]
  ds_read_b64_tr_b16 v[178:179], v190 offset:20992
  v_mfma_f32_16x16x32_bf16 v[60:63], v[108:111], v[132:135], v[60:63]
  ds_read_b64_tr_b16 v[180:181], v191 offset:20480
  v_mfma_f32_16x16x32_bf16 v[56:59], v[104:107], v[132:135], v[56:59]
  ds_read_b64_tr_b16 v[182:183], v191 offset:20992
  v_mfma_f32_16x16x32_bf16 v[72:75], v[104:107], v[136:139], v[72:75]
  v_mfma_f32_16x16x32_bf16 v[76:79], v[108:111], v[136:139], v[76:79]
  v_mfma_f32_16x16x32_bf16 v[80:83], v[112:115], v[136:139], v[80:83]
  v_mfma_f32_16x16x32_bf16 v[84:87], v[116:119], v[136:139], v[84:87]
  v_mfma_f32_16x16x32_bf16 v[100:103], v[116:119], v[140:143], v[100:103]
  v_mfma_f32_16x16x32_bf16 v[96:99], v[112:115], v[140:143], v[96:99]
  v_mfma_f32_16x16x32_bf16 v[92:95], v[108:111], v[140:143], v[92:95]
  v_mfma_f32_16x16x32_bf16 v[88:91], v[104:107], v[140:143], v[88:91]
  s_waitcnt lgkmcnt(0)
  s_barrier
  v_mfma_f32_16x16x32_bf16 v[8:11], v[160:163], v[144:147], v[8:11]
  ds_read_b128 v[104:107], v184 offset:0
  v_mfma_f32_16x16x32_bf16 v[12:15], v[160:163], v[148:151], v[12:15]
  ds_read_b64_tr_b16 v[120:121], v188 offset:0
  v_mfma_f32_16x16x32_bf16 v[16:19], v[160:163], v[152:155], v[16:19]
  ds_read_b64_tr_b16 v[122:123], v188 offset:512
  v_mfma_f32_16x16x32_bf16 v[20:23], v[160:163], v[156:159], v[20:23]
  ds_read_b128 v[108:111], v184 offset:2048
  v_mfma_f32_16x16x32_bf16 v[36:39], v[164:167], v[156:159], v[36:39]
  ds_read_b128 v[112:115], v184 offset:4096
  v_mfma_f32_16x16x32_bf16 v[32:35], v[164:167], v[152:155], v[32:35]
  ds_read_b128 v[116:119], v184 offset:6144
  v_mfma_f32_16x16x32_bf16 v[28:31], v[164:167], v[148:151], v[28:31]
  ds_read_b64_tr_b16 v[124:125], v189 offset:0
  v_mfma_f32_16x16x32_bf16 v[24:27], v[164:167], v[144:147], v[24:27]
  ds_read_b64_tr_b16 v[126:127], v189 offset:512
  v_mfma_f32_16x16x32_bf16 v[40:43], v[144:147], v[168:171], v[40:43]
  ds_read_b64_tr_b16 v[128:129], v188 offset:8192
  v_mfma_f32_16x16x32_bf16 v[44:47], v[148:151], v[168:171], v[44:47]
  ds_read_b64_tr_b16 v[130:131], v188 offset:8704
  v_mfma_f32_16x16x32_bf16 v[48:51], v[152:155], v[168:171], v[48:51]
  ds_read_b64_tr_b16 v[132:133], v189 offset:8192
  v_mfma_f32_16x16x32_bf16 v[52:55], v[156:159], v[168:171], v[52:55]
  ds_read_b64_tr_b16 v[134:135], v189 offset:8704
  v_mfma_f32_16x16x32_bf16 v[68:71], v[156:159], v[172:175], v[68:71]
  ds_read_b64_tr_b16 v[136:137], v188 offset:16384
  v_mfma_f32_16x16x32_bf16 v[64:67], v[152:155], v[172:175], v[64:67]
  ds_read_b64_tr_b16 v[138:139], v188 offset:16896
  v_mfma_f32_16x16x32_bf16 v[60:63], v[148:151], v[172:175], v[60:63]
  ds_read_b64_tr_b16 v[140:141], v189 offset:16384
  v_mfma_f32_16x16x32_bf16 v[56:59], v[144:147], v[172:175], v[56:59]
  ds_read_b64_tr_b16 v[142:143], v189 offset:16896
  v_mfma_f32_16x16x32_bf16 v[72:75], v[144:147], v[176:179], v[72:75]
  v_mfma_f32_16x16x32_bf16 v[76:79], v[148:151], v[176:179], v[76:79]
  v_mfma_f32_16x16x32_bf16 v[80:83], v[152:155], v[176:179], v[80:83]
  v_mfma_f32_16x16x32_bf16 v[84:87], v[156:159], v[176:179], v[84:87]
  v_mfma_f32_16x16x32_bf16 v[100:103], v[156:159], v[180:183], v[100:103]
  v_mfma_f32_16x16x32_bf16 v[96:99], v[152:155], v[180:183], v[96:99]
  v_mfma_f32_16x16x32_bf16 v[92:95], v[148:151], v[180:183], v[92:95]
  v_mfma_f32_16x16x32_bf16 v[88:91], v[144:147], v[180:183], v[88:91]
  s_waitcnt lgkmcnt(0)
  v_mfma_f32_16x16x32_bf16 v[8:11], v[120:123], v[104:107], v[8:11]
  ds_read_b128 v[144:147], v185 offset:0
  v_mfma_f32_16x16x32_bf16 v[12:15], v[120:123], v[108:111], v[12:15]
  ds_read_b64_tr_b16 v[160:161], v188 offset:4096
  v_mfma_f32_16x16x32_bf16 v[16:19], v[120:123], v[112:115], v[16:19]
  ds_read_b64_tr_b16 v[162:163], v188 offset:4608
  v_mfma_f32_16x16x32_bf16 v[20:23], v[120:123], v[116:119], v[20:23]
  ds_read_b128 v[148:151], v185 offset:2048
  v_mfma_f32_16x16x32_bf16 v[36:39], v[124:127], v[116:119], v[36:39]
  ds_read_b128 v[152:155], v185 offset:4096
  v_mfma_f32_16x16x32_bf16 v[32:35], v[124:127], v[112:115], v[32:35]
  ds_read_b128 v[156:159], v185 offset:6144
  v_mfma_f32_16x16x32_bf16 v[28:31], v[124:127], v[108:111], v[28:31]
  ds_read_b64_tr_b16 v[164:165], v189 offset:4096
  v_mfma_f32_16x16x32_bf16 v[24:27], v[124:127], v[104:107], v[24:27]
  ds_read_b64_tr_b16 v[166:167], v189 offset:4608
  v_mfma_f32_16x16x32_bf16 v[40:43], v[104:107], v[128:131], v[40:43]
  ds_read_b64_tr_b16 v[168:169], v188 offset:12288
  v_mfma_f32_16x16x32_bf16 v[44:47], v[108:111], v[128:131], v[44:47]
  ds_read_b64_tr_b16 v[170:171], v188 offset:12800
  v_mfma_f32_16x16x32_bf16 v[48:51], v[112:115], v[128:131], v[48:51]
  ds_read_b64_tr_b16 v[172:173], v189 offset:12288
  v_mfma_f32_16x16x32_bf16 v[52:55], v[116:119], v[128:131], v[52:55]
  ds_read_b64_tr_b16 v[174:175], v189 offset:12800
  v_mfma_f32_16x16x32_bf16 v[68:71], v[116:119], v[132:135], v[68:71]
  ds_read_b64_tr_b16 v[176:177], v188 offset:20480
  v_mfma_f32_16x16x32_bf16 v[64:67], v[112:115], v[132:135], v[64:67]
  ds_read_b64_tr_b16 v[178:179], v188 offset:20992
  v_mfma_f32_16x16x32_bf16 v[60:63], v[108:111], v[132:135], v[60:63]
  ds_read_b64_tr_b16 v[180:181], v189 offset:20480
  v_mfma_f32_16x16x32_bf16 v[56:59], v[104:107], v[132:135], v[56:59]
  ds_read_b64_tr_b16 v[182:183], v189 offset:20992
  v_mfma_f32_16x16x32_bf16 v[72:75], v[104:107], v[136:139], v[72:75]
  v_mfma_f32_16x16x32_bf16 v[76:79], v[108:111], v[136:139], v[76:79]
  v_mfma_f32_16x16x32_bf16 v[80:83], v[112:115], v[136:139], v[80:83]
  v_mfma_f32_16x16x32_bf16 v[84:87], v[116:119], v[136:139], v[84:87]
  v_mfma_f32_16x16x32_bf16 v[100:103], v[116:119], v[140:143], v[100:103]
  v_mfma_f32_16x16x32_bf16 v[96:99], v[112:115], v[140:143], v[96:99]
  v_mfma_f32_16x16x32_bf16 v[92:95], v[108:111], v[140:143], v[92:95]
  v_mfma_f32_16x16x32_bf16 v[88:91], v[104:107], v[140:143], v[88:91]
  s_waitcnt lgkmcnt(0)
  s_barrier
  v_mfma_f32_16x16x32_bf16 v[8:11], v[160:163], v[144:147], v[8:11]
  ds_read_b128 v[104:107], v184 offset:40960
  v_mfma_f32_16x16x32_bf16 v[12:15], v[160:163], v[148:151], v[12:15]
  ds_read_b64_tr_b16 v[120:121], v188 offset:40960
  v_mfma_f32_16x16x32_bf16 v[16:19], v[160:163], v[152:155], v[16:19]
  ds_read_b64_tr_b16 v[122:123], v188 offset:41472
  v_mfma_f32_16x16x32_bf16 v[20:23], v[160:163], v[156:159], v[20:23]
  ds_read_b128 v[108:111], v184 offset:43008
  v_mfma_f32_16x16x32_bf16 v[36:39], v[164:167], v[156:159], v[36:39]
  ds_read_b128 v[112:115], v184 offset:45056
  v_mfma_f32_16x16x32_bf16 v[32:35], v[164:167], v[152:155], v[32:35]
  ds_read_b128 v[116:119], v184 offset:47104
  v_mfma_f32_16x16x32_bf16 v[28:31], v[164:167], v[148:151], v[28:31]
  ds_read_b64_tr_b16 v[124:125], v189 offset:40960
  v_mfma_f32_16x16x32_bf16 v[24:27], v[164:167], v[144:147], v[24:27]
  ds_read_b64_tr_b16 v[126:127], v189 offset:41472
  v_mfma_f32_16x16x32_bf16 v[40:43], v[144:147], v[168:171], v[40:43]
  ds_read_b64_tr_b16 v[128:129], v188 offset:49152
  v_mfma_f32_16x16x32_bf16 v[44:47], v[148:151], v[168:171], v[44:47]
  ds_read_b64_tr_b16 v[130:131], v188 offset:49664
  v_mfma_f32_16x16x32_bf16 v[48:51], v[152:155], v[168:171], v[48:51]
  ds_read_b64_tr_b16 v[132:133], v189 offset:49152
  v_mfma_f32_16x16x32_bf16 v[52:55], v[156:159], v[168:171], v[52:55]
  ds_read_b64_tr_b16 v[134:135], v189 offset:49664
  v_mfma_f32_16x16x32_bf16 v[68:71], v[156:159], v[172:175], v[68:71]
  ds_read_b64_tr_b16 v[136:137], v188 offset:57344
  v_mfma_f32_16x16x32_bf16 v[64:67], v[152:155], v[172:175], v[64:67]
  ds_read_b64_tr_b16 v[138:139], v188 offset:57856
  v_mfma_f32_16x16x32_bf16 v[60:63], v[148:151], v[172:175], v[60:63]
  ds_read_b64_tr_b16 v[140:141], v189 offset:57344
  v_mfma_f32_16x16x32_bf16 v[56:59], v[144:147], v[172:175], v[56:59]
  ds_read_b64_tr_b16 v[142:143], v189 offset:57856
  v_mfma_f32_16x16x32_bf16 v[72:75], v[144:147], v[176:179], v[72:75]
  v_mfma_f32_16x16x32_bf16 v[76:79], v[148:151], v[176:179], v[76:79]
  v_mfma_f32_16x16x32_bf16 v[80:83], v[152:155], v[176:179], v[80:83]
  v_mfma_f32_16x16x32_bf16 v[84:87], v[156:159], v[176:179], v[84:87]
  v_mfma_f32_16x16x32_bf16 v[100:103], v[156:159], v[180:183], v[100:103]
  v_mfma_f32_16x16x32_bf16 v[96:99], v[152:155], v[180:183], v[96:99]
  v_mfma_f32_16x16x32_bf16 v[92:95], v[148:151], v[180:183], v[92:95]
  v_mfma_f32_16x16x32_bf16 v[88:91], v[144:147], v[180:183], v[88:91]
  s_waitcnt lgkmcnt(0)
  v_mfma_f32_16x16x32_bf16 v[8:11], v[120:123], v[104:107], v[8:11]
  ds_read_b128 v[144:147], v185 offset:40960
  v_mfma_f32_16x16x32_bf16 v[12:15], v[120:123], v[108:111], v[12:15]
  ds_read_b64_tr_b16 v[160:161], v188 offset:45056
  v_mfma_f32_16x16x32_bf16 v[16:19], v[120:123], v[112:115], v[16:19]
  ds_read_b64_tr_b16 v[162:163], v188 offset:45568
  v_mfma_f32_16x16x32_bf16 v[20:23], v[120:123], v[116:119], v[20:23]
  ds_read_b128 v[148:151], v185 offset:43008
  v_mfma_f32_16x16x32_bf16 v[36:39], v[124:127], v[116:119], v[36:39]
  ds_read_b128 v[152:155], v185 offset:45056
  v_mfma_f32_16x16x32_bf16 v[32:35], v[124:127], v[112:115], v[32:35]
  ds_read_b128 v[156:159], v185 offset:47104
  v_mfma_f32_16x16x32_bf16 v[28:31], v[124:127], v[108:111], v[28:31]
  ds_read_b64_tr_b16 v[164:165], v189 offset:45056
  v_mfma_f32_16x16x32_bf16 v[24:27], v[124:127], v[104:107], v[24:27]
  ds_read_b64_tr_b16 v[166:167], v189 offset:45568
  v_mfma_f32_16x16x32_bf16 v[40:43], v[104:107], v[128:131], v[40:43]
  ds_read_b64_tr_b16 v[168:169], v188 offset:53248
  v_mfma_f32_16x16x32_bf16 v[44:47], v[108:111], v[128:131], v[44:47]
  ds_read_b64_tr_b16 v[170:171], v188 offset:53760
  v_mfma_f32_16x16x32_bf16 v[48:51], v[112:115], v[128:131], v[48:51]
  ds_read_b64_tr_b16 v[172:173], v189 offset:53248
  v_mfma_f32_16x16x32_bf16 v[52:55], v[116:119], v[128:131], v[52:55]
  ds_read_b64_tr_b16 v[174:175], v189 offset:53760
  v_mfma_f32_16x16x32_bf16 v[68:71], v[116:119], v[132:135], v[68:71]
  ds_read_b64_tr_b16 v[176:177], v188 offset:61440
  v_mfma_f32_16x16x32_bf16 v[64:67], v[112:115], v[132:135], v[64:67]
  ds_read_b64_tr_b16 v[178:179], v188 offset:61952
  v_mfma_f32_16x16x32_bf16 v[60:63], v[108:111], v[132:135], v[60:63]
  ds_read_b64_tr_b16 v[180:181], v189 offset:61440
  v_mfma_f32_16x16x32_bf16 v[56:59], v[104:107], v[132:135], v[56:59]
  ds_read_b64_tr_b16 v[182:183], v189 offset:61952
  v_mfma_f32_16x16x32_bf16 v[72:75], v[104:107], v[136:139], v[72:75]
  v_mfma_f32_16x16x32_bf16 v[76:79], v[108:111], v[136:139], v[76:79]
  v_mfma_f32_16x16x32_bf16 v[80:83], v[112:115], v[136:139], v[80:83]
  v_mfma_f32_16x16x32_bf16 v[84:87], v[116:119], v[136:139], v[84:87]
  v_mfma_f32_16x16x32_bf16 v[100:103], v[116:119], v[140:143], v[100:103]
  v_mfma_f32_16x16x32_bf16 v[96:99], v[112:115], v[140:143], v[96:99]
  v_mfma_f32_16x16x32_bf16 v[92:95], v[108:111], v[140:143], v[92:95]
  v_mfma_f32_16x16x32_bf16 v[88:91], v[104:107], v[140:143], v[88:91]
  s_waitcnt lgkmcnt(0)
  s_barrier
  v_mfma_f32_16x16x32_bf16 v[8:11], v[160:163], v[144:147], v[8:11]
  ds_read_b128 v[104:107], v186 offset:0
  v_mfma_f32_16x16x32_bf16 v[12:15], v[160:163], v[148:151], v[12:15]
  ds_read_b64_tr_b16 v[120:121], v190 offset:0
  v_mfma_f32_16x16x32_bf16 v[16:19], v[160:163], v[152:155], v[16:19]
  ds_read_b64_tr_b16 v[122:123], v190 offset:512
  v_mfma_f32_16x16x32_bf16 v[20:23], v[160:163], v[156:159], v[20:23]
  ds_read_b128 v[108:111], v186 offset:2048
  v_mfma_f32_16x16x32_bf16 v[36:39], v[164:167], v[156:159], v[36:39]
  ds_read_b128 v[112:115], v186 offset:4096
  v_mfma_f32_16x16x32_bf16 v[32:35], v[164:167], v[152:155], v[32:35]
  ds_read_b128 v[116:119], v186 offset:6144
  v_mfma_f32_16x16x32_bf16 v[28:31], v[164:167], v[148:151], v[28:31]
  ds_read_b64_tr_b16 v[124:125], v191 offset:0
  v_mfma_f32_16x16x32_bf16 v[24:27], v[164:167], v[144:147], v[24:27]
  ds_read_b64_tr_b16 v[126:127], v191 offset:512
  v_mfma_f32_16x16x32_bf16 v[40:43], v[144:147], v[168:171], v[40:43]
  ds_read_b64_tr_b16 v[128:129], v190 offset:8192
  v_mfma_f32_16x16x32_bf16 v[44:47], v[148:151], v[168:171], v[44:47]
  ds_read_b64_tr_b16 v[130:131], v190 offset:8704
  v_mfma_f32_16x16x32_bf16 v[48:51], v[152:155], v[168:171], v[48:51]
  ds_read_b64_tr_b16 v[132:133], v191 offset:8192
  v_mfma_f32_16x16x32_bf16 v[52:55], v[156:159], v[168:171], v[52:55]
  ds_read_b64_tr_b16 v[134:135], v191 offset:8704
  v_mfma_f32_16x16x32_bf16 v[68:71], v[156:159], v[172:175], v[68:71]
  ds_read_b64_tr_b16 v[136:137], v190 offset:16384
  v_mfma_f32_16x16x32_bf16 v[64:67], v[152:155], v[172:175], v[64:67]
  ds_read_b64_tr_b16 v[138:139], v190 offset:16896
  v_mfma_f32_16x16x32_bf16 v[60:63], v[148:151], v[172:175], v[60:63]
  ds_read_b64_tr_b16 v[140:141], v191 offset:16384
  v_mfma_f32_16x16x32_bf16 v[56:59], v[144:147], v[172:175], v[56:59]
  ds_read_b64_tr_b16 v[142:143], v191 offset:16896
  v_mfma_f32_16x16x32_bf16 v[72:75], v[144:147], v[176:179], v[72:75]
  v_mfma_f32_16x16x32_bf16 v[76:79], v[148:151], v[176:179], v[76:79]
  v_mfma_f32_16x16x32_bf16 v[80:83], v[152:155], v[176:179], v[80:83]
  v_mfma_f32_16x16x32_bf16 v[84:87], v[156:159], v[176:179], v[84:87]
  v_mfma_f32_16x16x32_bf16 v[100:103], v[156:159], v[180:183], v[100:103]
  v_mfma_f32_16x16x32_bf16 v[96:99], v[152:155], v[180:183], v[96:99]
  v_mfma_f32_16x16x32_bf16 v[92:95], v[148:151], v[180:183], v[92:95]
  v_mfma_f32_16x16x32_bf16 v[88:91], v[144:147], v[180:183], v[88:91]
  s_waitcnt lgkmcnt(0)
  v_mfma_f32_16x16x32_bf16 v[8:11], v[120:123], v[104:107], v[8:11]
  ds_read_b128 v[144:147], v187 offset:0
  v_mfma_f32_16x16x32_bf16 v[12:15], v[120:123], v[108:111], v[12:15]
  ds_read_b64_tr_b16 v[160:161], v190 offset:4096
  v_mfma_f32_16x16x32_bf16 v[16:19], v[120:123], v[112:115], v[16:19]
  ds_read_b64_tr_b16 v[162:163], v190 offset:4608
  v_mfma_f32_16x16x32_bf16 v[20:23], v[120:123], v[116:119], v[20:23]
  ds_read_b128 v[148:151], v187 offset:2048
  v_mfma_f32_16x16x32_bf16 v[36:39], v[124:127], v[116:119], v[36:39]
  ds_read_b128 v[152:155], v187 offset:4096
  v_mfma_f32_16x16x32_bf16 v[32:35], v[124:127], v[112:115], v[32:35]
  ds_read_b128 v[156:159], v187 offset:6144
  v_mfma_f32_16x16x32_bf16 v[28:31], v[124:127], v[108:111], v[28:31]
  ds_read_b64_tr_b16 v[164:165], v191 offset:4096
  v_mfma_f32_16x16x32_bf16 v[24:27], v[124:127], v[104:107], v[24:27]
  ds_read_b64_tr_b16 v[166:167], v191 offset:4608
  v_mfma_f32_16x16x32_bf16 v[40:43], v[104:107], v[128:131], v[40:43]
  ds_read_b64_tr_b16 v[168:169], v190 offset:12288
  v_mfma_f32_16x16x32_bf16 v[44:47], v[108:111], v[128:131], v[44:47]
  ds_read_b64_tr_b16 v[170:171], v190 offset:12800
  v_mfma_f32_16x16x32_bf16 v[48:51], v[112:115], v[128:131], v[48:51]
  ds_read_b64_tr_b16 v[172:173], v191 offset:12288
  v_mfma_f32_16x16x32_bf16 v[52:55], v[116:119], v[128:131], v[52:55]
  ds_read_b64_tr_b16 v[174:175], v191 offset:12800
  v_mfma_f32_16x16x32_bf16 v[68:71], v[116:119], v[132:135], v[68:71]
  ds_read_b64_tr_b16 v[176:177], v190 offset:20480
  v_mfma_f32_16x16x32_bf16 v[64:67], v[112:115], v[132:135], v[64:67]
  ds_read_b64_tr_b16 v[178:179], v190 offset:20992
  v_mfma_f32_16x16x32_bf16 v[60:63], v[108:111], v[132:135], v[60:63]
  ds_read_b64_tr_b16 v[180:181], v191 offset:20480
  v_mfma_f32_16x16x32_bf16 v[56:59], v[104:107], v[132:135], v[56:59]
  ds_read_b64_tr_b16 v[182:183], v191 offset:20992
  v_mfma_f32_16x16x32_bf16 v[72:75], v[104:107], v[136:139], v[72:75]
  v_mfma_f32_16x16x32_bf16 v[76:79], v[108:111], v[136:139], v[76:79]
  v_mfma_f32_16x16x32_bf16 v[80:83], v[112:115], v[136:139], v[80:83]
  v_mfma_f32_16x16x32_bf16 v[84:87], v[116:119], v[136:139], v[84:87]
  v_mfma_f32_16x16x32_bf16 v[100:103], v[116:119], v[140:143], v[100:103]
  v_mfma_f32_16x16x32_bf16 v[96:99], v[112:115], v[140:143], v[96:99]
  v_mfma_f32_16x16x32_bf16 v[92:95], v[108:111], v[140:143], v[92:95]
  v_mfma_f32_16x16x32_bf16 v[88:91], v[104:107], v[140:143], v[88:91]
  s_waitcnt lgkmcnt(0)
  s_barrier
  v_mfma_f32_16x16x32_bf16 v[8:11], v[160:163], v[144:147], v[8:11]
  ds_read_b128 v[104:107], v184 offset:0
  v_mfma_f32_16x16x32_bf16 v[12:15], v[160:163], v[148:151], v[12:15]
  ds_read_b64_tr_b16 v[120:121], v188 offset:0
  v_mfma_f32_16x16x32_bf16 v[16:19], v[160:163], v[152:155], v[16:19]
  ds_read_b64_tr_b16 v[122:123], v188 offset:512
  v_mfma_f32_16x16x32_bf16 v[20:23], v[160:163], v[156:159], v[20:23]
  ds_read_b128 v[108:111], v184 offset:2048
  v_mfma_f32_16x16x32_bf16 v[36:39], v[164:167], v[156:159], v[36:39]
  ds_read_b128 v[112:115], v184 offset:4096
  v_mfma_f32_16x16x32_bf16 v[32:35], v[164:167], v[152:155], v[32:35]
  ds_read_b128 v[116:119], v184 offset:6144
  v_mfma_f32_16x16x32_bf16 v[28:31], v[164:167], v[148:151], v[28:31]
  ds_read_b64_tr_b16 v[124:125], v189 offset:0
  v_mfma_f32_16x16x32_bf16 v[24:27], v[164:167], v[144:147], v[24:27]
  ds_read_b64_tr_b16 v[126:127], v189 offset:512
  v_mfma_f32_16x16x32_bf16 v[40:43], v[144:147], v[168:171], v[40:43]
  ds_read_b64_tr_b16 v[128:129], v188 offset:8192
  v_mfma_f32_16x16x32_bf16 v[44:47], v[148:151], v[168:171], v[44:47]
  ds_read_b64_tr_b16 v[130:131], v188 offset:8704
  v_mfma_f32_16x16x32_bf16 v[48:51], v[152:155], v[168:171], v[48:51]
  ds_read_b64_tr_b16 v[132:133], v189 offset:8192
  v_mfma_f32_16x16x32_bf16 v[52:55], v[156:159], v[168:171], v[52:55]
  ds_read_b64_tr_b16 v[134:135], v189 offset:8704
  v_mfma_f32_16x16x32_bf16 v[68:71], v[156:159], v[172:175], v[68:71]
  ds_read_b64_tr_b16 v[136:137], v188 offset:16384
  v_mfma_f32_16x16x32_bf16 v[64:67], v[152:155], v[172:175], v[64:67]
  ds_read_b64_tr_b16 v[138:139], v188 offset:16896
  v_mfma_f32_16x16x32_bf16 v[60:63], v[148:151], v[172:175], v[60:63]
  ds_read_b64_tr_b16 v[140:141], v189 offset:16384
  v_mfma_f32_16x16x32_bf16 v[56:59], v[144:147], v[172:175], v[56:59]
  ds_read_b64_tr_b16 v[142:143], v189 offset:16896
  v_mfma_f32_16x16x32_bf16 v[72:75], v[144:147], v[176:179], v[72:75]
  v_mfma_f32_16x16x32_bf16 v[76:79], v[148:151], v[176:179], v[76:79]
  v_mfma_f32_16x16x32_bf16 v[80:83], v[152:155], v[176:179], v[80:83]
  v_mfma_f32_16x16x32_bf16 v[84:87], v[156:159], v[176:179], v[84:87]
  v_mfma_f32_16x16x32_bf16 v[100:103], v[156:159], v[180:183], v[100:103]
  v_mfma_f32_16x16x32_bf16 v[96:99], v[152:155], v[180:183], v[96:99]
  v_mfma_f32_16x16x32_bf16 v[92:95], v[148:151], v[180:183], v[92:95]
  v_mfma_f32_16x16x32_bf16 v[88:91], v[144:147], v[180:183], v[88:91]
  s_waitcnt lgkmcnt(0)
  v_mfma_f32_16x16x32_bf16 v[8:11], v[120:123], v[104:107], v[8:11]
  ds_read_b128 v[144:147], v185 offset:0
  v_mfma_f32_16x16x32_bf16 v[12:15], v[120:123], v[108:111], v[12:15]
  ds_read_b64_tr_b16 v[160:161], v188 offset:4096
  v_mfma_f32_16x16x32_bf16 v[16:19], v[120:123], v[112:115], v[16:19]
  ds_read_b64_tr_b16 v[162:163], v188 offset:4608
  v_mfma_f32_16x16x32_bf16 v[20:23], v[120:123], v[116:119], v[20:23]
  ds_read_b128 v[148:151], v185 offset:2048
  v_mfma_f32_16x16x32_bf16 v[36:39], v[124:127], v[116:119], v[36:39]
  ds_read_b128 v[152:155], v185 offset:4096
  v_mfma_f32_16x16x32_bf16 v[32:35], v[124:127], v[112:115], v[32:35]
  ds_read_b128 v[156:159], v185 offset:6144
  v_mfma_f32_16x16x32_bf16 v[28:31], v[124:127], v[108:111], v[28:31]
  ds_read_b64_tr_b16 v[164:165], v189 offset:4096
  v_mfma_f32_16x16x32_bf16 v[24:27], v[124:127], v[104:107], v[24:27]
  ds_read_b64_tr_b16 v[166:167], v189 offset:4608
  v_mfma_f32_16x16x32_bf16 v[40:43], v[104:107], v[128:131], v[40:43]
  ds_read_b64_tr_b16 v[168:169], v188 offset:12288
  v_mfma_f32_16x16x32_bf16 v[44:47], v[108:111], v[128:131], v[44:47]
  ds_read_b64_tr_b16 v[170:171], v188 offset:12800
  v_mfma_f32_16x16x32_bf16 v[48:51], v[112:115], v[128:131], v[48:51]
  ds_read_b64_tr_b16 v[172:173], v189 offset:12288
  v_mfma_f32_16x16x32_bf16 v[52:55], v[116:119], v[128:131], v[52:55]
  ds_read_b64_tr_b16 v[174:175], v189 offset:12800
  v_mfma_f32_16x16x32_bf16 v[68:71], v[116:119], v[132:135], v[68:71]
  ds_read_b64_tr_b16 v[176:177], v188 offset:20480
  v_mfma_f32_16x16x32_bf16 v[64:67], v[112:115], v[132:135], v[64:67]
  ds_read_b64_tr_b16 v[178:179], v188 offset:20992
  v_mfma_f32_16x16x32_bf16 v[60:63], v[108:111], v[132:135], v[60:63]
  ds_read_b64_tr_b16 v[180:181], v189 offset:20480
  v_mfma_f32_16x16x32_bf16 v[56:59], v[104:107], v[132:135], v[56:59]
  ds_read_b64_tr_b16 v[182:183], v189 offset:20992
  v_mfma_f32_16x16x32_bf16 v[72:75], v[104:107], v[136:139], v[72:75]
  v_mfma_f32_16x16x32_bf16 v[76:79], v[108:111], v[136:139], v[76:79]
  v_mfma_f32_16x16x32_bf16 v[80:83], v[112:115], v[136:139], v[80:83]
  v_mfma_f32_16x16x32_bf16 v[84:87], v[116:119], v[136:139], v[84:87]
  v_mfma_f32_16x16x32_bf16 v[100:103], v[116:119], v[140:143], v[100:103]
  v_mfma_f32_16x16x32_bf16 v[96:99], v[112:115], v[140:143], v[96:99]
  v_mfma_f32_16x16x32_bf16 v[92:95], v[108:111], v[140:143], v[92:95]
  v_mfma_f32_16x16x32_bf16 v[88:91], v[104:107], v[140:143], v[88:91]
  s_waitcnt lgkmcnt(0)
  s_barrier
  v_mfma_f32_16x16x32_bf16 v[8:11], v[160:163], v[144:147], v[8:11]
  ds_read_b128 v[104:107], v184 offset:40960
  v_mfma_f32_16x16x32_bf16 v[12:15], v[160:163], v[148:151], v[12:15]
  ds_read_b64_tr_b16 v[120:121], v188 offset:40960
  v_mfma_f32_16x16x32_bf16 v[16:19], v[160:163], v[152:155], v[16:19]
  ds_read_b64_tr_b16 v[122:123], v188 offset:41472
  v_mfma_f32_16x16x32_bf16 v[20:23], v[160:163], v[156:159], v[20:23]
  ds_read_b128 v[108:111], v184 offset:43008
  v_mfma_f32_16x16x32_bf16 v[36:39], v[164:167], v[156:159], v[36:39]
  ds_read_b128 v[112:115], v184 offset:45056
  v_mfma_f32_16x16x32_bf16 v[32:35], v[164:167], v[152:155], v[32:35]
  ds_read_b128 v[116:119], v184 offset:47104
  v_mfma_f32_16x16x32_bf16 v[28:31], v[164:167], v[148:151], v[28:31]
  ds_read_b64_tr_b16 v[124:125], v189 offset:40960
  v_mfma_f32_16x16x32_bf16 v[24:27], v[164:167], v[144:147], v[24:27]
  ds_read_b64_tr_b16 v[126:127], v189 offset:41472
  v_mfma_f32_16x16x32_bf16 v[40:43], v[144:147], v[168:171], v[40:43]
  ds_read_b64_tr_b16 v[128:129], v188 offset:49152
  v_mfma_f32_16x16x32_bf16 v[44:47], v[148:151], v[168:171], v[44:47]
  ds_read_b64_tr_b16 v[130:131], v188 offset:49664
  v_mfma_f32_16x16x32_bf16 v[48:51], v[152:155], v[168:171], v[48:51]
  ds_read_b64_tr_b16 v[132:133], v189 offset:49152
  v_mfma_f32_16x16x32_bf16 v[52:55], v[156:159], v[168:171], v[52:55]
  ds_read_b64_tr_b16 v[134:135], v189 offset:49664
  v_mfma_f32_16x16x32_bf16 v[68:71], v[156:159], v[172:175], v[68:71]
  ds_read_b64_tr_b16 v[136:137], v188 offset:57344
  v_mfma_f32_16x16x32_bf16 v[64:67], v[152:155], v[172:175], v[64:67]
  ds_read_b64_tr_b16 v[138:139], v188 offset:57856
  v_mfma_f32_16x16x32_bf16 v[60:63], v[148:151], v[172:175], v[60:63]
  ds_read_b64_tr_b16 v[140:141], v189 offset:57344
  v_mfma_f32_16x16x32_bf16 v[56:59], v[144:147], v[172:175], v[56:59]
  ds_read_b64_tr_b16 v[142:143], v189 offset:57856
  v_mfma_f32_16x16x32_bf16 v[72:75], v[144:147], v[176:179], v[72:75]
  v_mfma_f32_16x16x32_bf16 v[76:79], v[148:151], v[176:179], v[76:79]
  v_mfma_f32_16x16x32_bf16 v[80:83], v[152:155], v[176:179], v[80:83]
  v_mfma_f32_16x16x32_bf16 v[84:87], v[156:159], v[176:179], v[84:87]
  v_mfma_f32_16x16x32_bf16 v[100:103], v[156:159], v[180:183], v[100:103]
  v_mfma_f32_16x16x32_bf16 v[96:99], v[152:155], v[180:183], v[96:99]
  v_mfma_f32_16x16x32_bf16 v[92:95], v[148:151], v[180:183], v[92:95]
  v_mfma_f32_16x16x32_bf16 v[88:91], v[144:147], v[180:183], v[88:91]
  s_waitcnt lgkmcnt(0)
  v_mfma_f32_16x16x32_bf16 v[8:11], v[120:123], v[104:107], v[8:11]
  ds_read_b128 v[144:147], v185 offset:40960
  v_mfma_f32_16x16x32_bf16 v[12:15], v[120:123], v[108:111], v[12:15]
  ds_read_b64_tr_b16 v[160:161], v188 offset:45056
  v_mfma_f32_16x16x32_bf16 v[16:19], v[120:123], v[112:115], v[16:19]
  ds_read_b64_tr_b16 v[162:163], v188 offset:45568
  v_mfma_f32_16x16x32_bf16 v[20:23], v[120:123], v[116:119], v[20:23]
  ds_read_b128 v[148:151], v185 offset:43008
  v_mfma_f32_16x16x32_bf16 v[36:39], v[124:127], v[116:119], v[36:39]
  ds_read_b128 v[152:155], v185 offset:45056
  v_mfma_f32_16x16x32_bf16 v[32:35], v[124:127], v[112:115], v[32:35]
  ds_read_b128 v[156:159], v185 offset:47104
  v_mfma_f32_16x16x32_bf16 v[28:31], v[124:127], v[108:111], v[28:31]
  ds_read_b64_tr_b16 v[164:165], v189 offset:45056
  v_mfma_f32_16x16x32_bf16 v[24:27], v[124:127], v[104:107], v[24:27]
  ds_read_b64_tr_b16 v[166:167], v189 offset:45568
  v_mfma_f32_16x16x32_bf16 v[40:43], v[104:107], v[128:131], v[40:43]
  ds_read_b64_tr_b16 v[168:169], v188 offset:53248
  v_mfma_f32_16x16x32_bf16 v[44:47], v[108:111], v[128:131], v[44:47]
  ds_read_b64_tr_b16 v[170:171], v188 offset:53760
  v_mfma_f32_16x16x32_bf16 v[48:51], v[112:115], v[128:131], v[48:51]
  ds_read_b64_tr_b16 v[172:173], v189 offset:53248
  v_mfma_f32_16x16x32_bf16 v[52:55], v[116:119], v[128:131], v[52:55]
  ds_read_b64_tr_b16 v[174:175], v189 offset:53760
  v_mfma_f32_16x16x32_bf16 v[68:71], v[116:119], v[132:135], v[68:71]
  ds_read_b64_tr_b16 v[176:177], v188 offset:61440
  v_mfma_f32_16x16x32_bf16 v[64:67], v[112:115], v[132:135], v[64:67]
  ds_read_b64_tr_b16 v[178:179], v188 offset:61952
  v_mfma_f32_16x16x32_bf16 v[60:63], v[108:111], v[132:135], v[60:63]
  ds_read_b64_tr_b16 v[180:181], v189 offset:61440
  v_mfma_f32_16x16x32_bf16 v[56:59], v[104:107], v[132:135], v[56:59]
  ds_read_b64_tr_b16 v[182:183], v189 offset:61952
  v_mfma_f32_16x16x32_bf16 v[72:75], v[104:107], v[136:139], v[72:75]
  v_mfma_f32_16x16x32_bf16 v[76:79], v[108:111], v[136:139], v[76:79]
  v_mfma_f32_16x16x32_bf16 v[80:83], v[112:115], v[136:139], v[80:83]
  v_mfma_f32_16x16x32_bf16 v[84:87], v[116:119], v[136:139], v[84:87]
  v_mfma_f32_16x16x32_bf16 v[100:103], v[116:119], v[140:143], v[100:103]
  v_mfma_f32_16x16x32_bf16 v[96:99], v[112:115], v[140:143], v[96:99]
  v_mfma_f32_16x16x32_bf16 v[92:95], v[108:111], v[140:143], v[92:95]
  v_mfma_f32_16x16x32_bf16 v[88:91], v[104:107], v[140:143], v[88:91]
  s_waitcnt lgkmcnt(0)
  s_barrier
  v_mfma_f32_16x16x32_bf16 v[8:11], v[160:163], v[144:147], v[8:11]
  ds_read_b128 v[104:107], v186 offset:0
  v_mfma_f32_16x16x32_bf16 v[12:15], v[160:163], v[148:151], v[12:15]
  ds_read_b64_tr_b16 v[120:121], v190 offset:0
  v_mfma_f32_16x16x32_bf16 v[16:19], v[160:163], v[152:155], v[16:19]
  ds_read_b64_tr_b16 v[122:123], v190 offset:512
  v_mfma_f32_16x16x32_bf16 v[20:23], v[160:163], v[156:159], v[20:23]
  ds_read_b128 v[108:111], v186 offset:2048
  v_mfma_f32_16x16x32_bf16 v[36:39], v[164:167], v[156:159], v[36:39]
  ds_read_b128 v[112:115], v186 offset:4096
  v_mfma_f32_16x16x32_bf16 v[32:35], v[164:167], v[152:155], v[32:35]
  ds_read_b128 v[116:119], v186 offset:6144
  v_mfma_f32_16x16x32_bf16 v[28:31], v[164:167], v[148:151], v[28:31]
  ds_read_b64_tr_b16 v[124:125], v191 offset:0
  v_mfma_f32_16x16x32_bf16 v[24:27], v[164:167], v[144:147], v[24:27]
  ds_read_b64_tr_b16 v[126:127], v191 offset:512
  v_mfma_f32_16x16x32_bf16 v[40:43], v[144:147], v[168:171], v[40:43]
  ds_read_b64_tr_b16 v[128:129], v190 offset:8192
  v_mfma_f32_16x16x32_bf16 v[44:47], v[148:151], v[168:171], v[44:47]
  ds_read_b64_tr_b16 v[130:131], v190 offset:8704
  v_mfma_f32_16x16x32_bf16 v[48:51], v[152:155], v[168:171], v[48:51]
  ds_read_b64_tr_b16 v[132:133], v191 offset:8192
  v_mfma_f32_16x16x32_bf16 v[52:55], v[156:159], v[168:171], v[52:55]
  ds_read_b64_tr_b16 v[134:135], v191 offset:8704
  v_mfma_f32_16x16x32_bf16 v[68:71], v[156:159], v[172:175], v[68:71]
  ds_read_b64_tr_b16 v[136:137], v190 offset:16384
  v_mfma_f32_16x16x32_bf16 v[64:67], v[152:155], v[172:175], v[64:67]
  ds_read_b64_tr_b16 v[138:139], v190 offset:16896
  v_mfma_f32_16x16x32_bf16 v[60:63], v[148:151], v[172:175], v[60:63]
  ds_read_b64_tr_b16 v[140:141], v191 offset:16384
  v_mfma_f32_16x16x32_bf16 v[56:59], v[144:147], v[172:175], v[56:59]
  ds_read_b64_tr_b16 v[142:143], v191 offset:16896
  v_mfma_f32_16x16x32_bf16 v[72:75], v[144:147], v[176:179], v[72:75]
  v_mfma_f32_16x16x32_bf16 v[76:79], v[148:151], v[176:179], v[76:79]
  v_mfma_f32_16x16x32_bf16 v[80:83], v[152:155], v[176:179], v[80:83]
  v_mfma_f32_16x16x32_bf16 v[84:87], v[156:159], v[176:179], v[84:87]
  v_mfma_f32_16x16x32_bf16 v[100:103], v[156:159], v[180:183], v[100:103]
  v_mfma_f32_16x16x32_bf16 v[96:99], v[152:155], v[180:183], v[96:99]
  v_mfma_f32_16x16x32_bf16 v[92:95], v[148:151], v[180:183], v[92:95]
  v_mfma_f32_16x16x32_bf16 v[88:91], v[144:147], v[180:183], v[88:91]
  s_waitcnt lgkmcnt(0)
  v_mfma_f32_16x16x32_bf16 v[8:11], v[120:123], v[104:107], v[8:11]
  ds_read_b128 v[144:147], v187 offset:0
  v_mfma_f32_16x16x32_bf16 v[12:15], v[120:123], v[108:111], v[12:15]
  ds_read_b64_tr_b16 v[160:161], v190 offset:4096
  v_mfma_f32_16x16x32_bf16 v[16:19], v[120:123], v[112:115], v[16:19]
  ds_read_b64_tr_b16 v[162:163], v190 offset:4608
  v_mfma_f32_16x16x32_bf16 v[20:23], v[120:123], v[116:119], v[20:23]
  ds_read_b128 v[148:151], v187 offset:2048
  v_mfma_f32_16x16x32_bf16 v[36:39], v[124:127], v[116:119], v[36:39]
  ds_read_b128 v[152:155], v187 offset:4096
  v_mfma_f32_16x16x32_bf16 v[32:35], v[124:127], v[112:115], v[32:35]
  ds_read_b128 v[156:159], v187 offset:6144
  v_mfma_f32_16x16x32_bf16 v[28:31], v[124:127], v[108:111], v[28:31]
  ds_read_b64_tr_b16 v[164:165], v191 offset:4096
  v_mfma_f32_16x16x32_bf16 v[24:27], v[124:127], v[104:107], v[24:27]
  ds_read_b64_tr_b16 v[166:167], v191 offset:4608
  v_mfma_f32_16x16x32_bf16 v[40:43], v[104:107], v[128:131], v[40:43]
  ds_read_b64_tr_b16 v[168:169], v190 offset:12288
  v_mfma_f32_16x16x32_bf16 v[44:47], v[108:111], v[128:131], v[44:47]
  ds_read_b64_tr_b16 v[170:171], v190 offset:12800
  v_mfma_f32_16x16x32_bf16 v[48:51], v[112:115], v[128:131], v[48:51]
  ds_read_b64_tr_b16 v[172:173], v191 offset:12288
  v_mfma_f32_16x16x32_bf16 v[52:55], v[116:119], v[128:131], v[52:55]
  ds_read_b64_tr_b16 v[174:175], v191 offset:12800
  v_mfma_f32_16x16x32_bf16 v[68:71], v[116:119], v[132:135], v[68:71]
  ds_read_b64_tr_b16 v[176:177], v190 offset:20480
  v_mfma_f32_16x16x32_bf16 v[64:67], v[112:115], v[132:135], v[64:67]
  ds_read_b64_tr_b16 v[178:179], v190 offset:20992
  v_mfma_f32_16x16x32_bf16 v[60:63], v[108:111], v[132:135], v[60:63]
  ds_read_b64_tr_b16 v[180:181], v191 offset:20480
  v_mfma_f32_16x16x32_bf16 v[56:59], v[104:107], v[132:135], v[56:59]
  ds_read_b64_tr_b16 v[182:183], v191 offset:20992
  v_mfma_f32_16x16x32_bf16 v[72:75], v[104:107], v[136:139], v[72:75]
  v_mfma_f32_16x16x32_bf16 v[76:79], v[108:111], v[136:139], v[76:79]
  v_mfma_f32_16x16x32_bf16 v[80:83], v[112:115], v[136:139], v[80:83]
  v_mfma_f32_16x16x32_bf16 v[84:87], v[116:119], v[136:139], v[84:87]
  v_mfma_f32_16x16x32_bf16 v[100:103], v[116:119], v[140:143], v[100:103]
  v_mfma_f32_16x16x32_bf16 v[96:99], v[112:115], v[140:143], v[96:99]
  v_mfma_f32_16x16x32_bf16 v[92:95], v[108:111], v[140:143], v[92:95]
  v_mfma_f32_16x16x32_bf16 v[88:91], v[104:107], v[140:143], v[88:91]
  s_waitcnt lgkmcnt(0)
  s_barrier
  v_mfma_f32_16x16x32_bf16 v[8:11], v[160:163], v[144:147], v[8:11]
  ds_read_b128 v[104:107], v184 offset:0
  v_mfma_f32_16x16x32_bf16 v[12:15], v[160:163], v[148:151], v[12:15]
  ds_read_b64_tr_b16 v[120:121], v188 offset:0
  v_mfma_f32_16x16x32_bf16 v[16:19], v[160:163], v[152:155], v[16:19]
  ds_read_b64_tr_b16 v[122:123], v188 offset:512
  v_mfma_f32_16x16x32_bf16 v[20:23], v[160:163], v[156:159], v[20:23]
  ds_read_b128 v[108:111], v184 offset:2048
  v_mfma_f32_16x16x32_bf16 v[36:39], v[164:167], v[156:159], v[36:39]
  ds_read_b128 v[112:115], v184 offset:4096
  v_mfma_f32_16x16x32_bf16 v[32:35], v[164:167], v[152:155], v[32:35]
  ds_read_b128 v[116:119], v184 offset:6144
  v_mfma_f32_16x16x32_bf16 v[28:31], v[164:167], v[148:151], v[28:31]
  ds_read_b64_tr_b16 v[124:125], v189 offset:0
  v_mfma_f32_16x16x32_bf16 v[24:27], v[164:167], v[144:147], v[24:27]
  ds_read_b64_tr_b16 v[126:127], v189 offset:512
  v_mfma_f32_16x16x32_bf16 v[40:43], v[144:147], v[168:171], v[40:43]
  ds_read_b64_tr_b16 v[128:129], v188 offset:8192
  v_mfma_f32_16x16x32_bf16 v[44:47], v[148:151], v[168:171], v[44:47]
  ds_read_b64_tr_b16 v[130:131], v188 offset:8704
  v_mfma_f32_16x16x32_bf16 v[48:51], v[152:155], v[168:171], v[48:51]
  ds_read_b64_tr_b16 v[132:133], v189 offset:8192
  v_mfma_f32_16x16x32_bf16 v[52:55], v[156:159], v[168:171], v[52:55]
  ds_read_b64_tr_b16 v[134:135], v189 offset:8704
  v_mfma_f32_16x16x32_bf16 v[68:71], v[156:159], v[172:175], v[68:71]
  ds_read_b64_tr_b16 v[136:137], v188 offset:16384
  v_mfma_f32_16x16x32_bf16 v[64:67], v[152:155], v[172:175], v[64:67]
  ds_read_b64_tr_b16 v[138:139], v188 offset:16896
  v_mfma_f32_16x16x32_bf16 v[60:63], v[148:151], v[172:175], v[60:63]
  ds_read_b64_tr_b16 v[140:141], v189 offset:16384
  v_mfma_f32_16x16x32_bf16 v[56:59], v[144:147], v[172:175], v[56:59]
  ds_read_b64_tr_b16 v[142:143], v189 offset:16896
  v_mfma_f32_16x16x32_bf16 v[72:75], v[144:147], v[176:179], v[72:75]
  v_mfma_f32_16x16x32_bf16 v[76:79], v[148:151], v[176:179], v[76:79]
  v_mfma_f32_16x16x32_bf16 v[80:83], v[152:155], v[176:179], v[80:83]
  v_mfma_f32_16x16x32_bf16 v[84:87], v[156:159], v[176:179], v[84:87]
  v_mfma_f32_16x16x32_bf16 v[100:103], v[156:159], v[180:183], v[100:103]
  v_mfma_f32_16x16x32_bf16 v[96:99], v[152:155], v[180:183], v[96:99]
  v_mfma_f32_16x16x32_bf16 v[92:95], v[148:151], v[180:183], v[92:95]
  v_mfma_f32_16x16x32_bf16 v[88:91], v[144:147], v[180:183], v[88:91]
  s_waitcnt lgkmcnt(0)
  v_mfma_f32_16x16x32_bf16 v[8:11], v[120:123], v[104:107], v[8:11]
  ds_read_b128 v[144:147], v185 offset:0
  v_mfma_f32_16x16x32_bf16 v[12:15], v[120:123], v[108:111], v[12:15]
  ds_read_b64_tr_b16 v[160:161], v188 offset:4096
  v_mfma_f32_16x16x32_bf16 v[16:19], v[120:123], v[112:115], v[16:19]
  ds_read_b64_tr_b16 v[162:163], v188 offset:4608
  v_mfma_f32_16x16x32_bf16 v[20:23], v[120:123], v[116:119], v[20:23]
  ds_read_b128 v[148:151], v185 offset:2048
  v_mfma_f32_16x16x32_bf16 v[36:39], v[124:127], v[116:119], v[36:39]
  ds_read_b128 v[152:155], v185 offset:4096
  v_mfma_f32_16x16x32_bf16 v[32:35], v[124:127], v[112:115], v[32:35]
  ds_read_b128 v[156:159], v185 offset:6144
  v_mfma_f32_16x16x32_bf16 v[28:31], v[124:127], v[108:111], v[28:31]
  ds_read_b64_tr_b16 v[164:165], v189 offset:4096
  v_mfma_f32_16x16x32_bf16 v[24:27], v[124:127], v[104:107], v[24:27]
  ds_read_b64_tr_b16 v[166:167], v189 offset:4608
  v_mfma_f32_16x16x32_bf16 v[40:43], v[104:107], v[128:131], v[40:43]
  ds_read_b64_tr_b16 v[168:169], v188 offset:12288
  v_mfma_f32_16x16x32_bf16 v[44:47], v[108:111], v[128:131], v[44:47]
  ds_read_b64_tr_b16 v[170:171], v188 offset:12800
  v_mfma_f32_16x16x32_bf16 v[48:51], v[112:115], v[128:131], v[48:51]
  ds_read_b64_tr_b16 v[172:173], v189 offset:12288
  v_mfma_f32_16x16x32_bf16 v[52:55], v[116:119], v[128:131], v[52:55]
  ds_read_b64_tr_b16 v[174:175], v189 offset:12800
  v_mfma_f32_16x16x32_bf16 v[68:71], v[116:119], v[132:135], v[68:71]
  ds_read_b64_tr_b16 v[176:177], v188 offset:20480
  v_mfma_f32_16x16x32_bf16 v[64:67], v[112:115], v[132:135], v[64:67]
  ds_read_b64_tr_b16 v[178:179], v188 offset:20992
  v_mfma_f32_16x16x32_bf16 v[60:63], v[108:111], v[132:135], v[60:63]
  ds_read_b64_tr_b16 v[180:181], v189 offset:20480
  v_mfma_f32_16x16x32_bf16 v[56:59], v[104:107], v[132:135], v[56:59]
  ds_read_b64_tr_b16 v[182:183], v189 offset:20992
  v_mfma_f32_16x16x32_bf16 v[72:75], v[104:107], v[136:139], v[72:75]
  v_mfma_f32_16x16x32_bf16 v[76:79], v[108:111], v[136:139], v[76:79]
  v_mfma_f32_16x16x32_bf16 v[80:83], v[112:115], v[136:139], v[80:83]
  v_mfma_f32_16x16x32_bf16 v[84:87], v[116:119], v[136:139], v[84:87]
  v_mfma_f32_16x16x32_bf16 v[100:103], v[116:119], v[140:143], v[100:103]
  v_mfma_f32_16x16x32_bf16 v[96:99], v[112:115], v[140:143], v[96:99]
  v_mfma_f32_16x16x32_bf16 v[92:95], v[108:111], v[140:143], v[92:95]
  v_mfma_f32_16x16x32_bf16 v[88:91], v[104:107], v[140:143], v[88:91]
  s_waitcnt lgkmcnt(0)
  s_barrier
  v_mfma_f32_16x16x32_bf16 v[8:11], v[160:163], v[144:147], v[8:11]
  ds_read_b128 v[104:107], v184 offset:40960
  v_mfma_f32_16x16x32_bf16 v[12:15], v[160:163], v[148:151], v[12:15]
  ds_read_b64_tr_b16 v[120:121], v188 offset:40960
  v_mfma_f32_16x16x32_bf16 v[16:19], v[160:163], v[152:155], v[16:19]
  ds_read_b64_tr_b16 v[122:123], v188 offset:41472
  v_mfma_f32_16x16x32_bf16 v[20:23], v[160:163], v[156:159], v[20:23]
  ds_read_b128 v[108:111], v184 offset:43008
  v_mfma_f32_16x16x32_bf16 v[36:39], v[164:167], v[156:159], v[36:39]
  ds_read_b128 v[112:115], v184 offset:45056
  v_mfma_f32_16x16x32_bf16 v[32:35], v[164:167], v[152:155], v[32:35]
  ds_read_b128 v[116:119], v184 offset:47104
  v_mfma_f32_16x16x32_bf16 v[28:31], v[164:167], v[148:151], v[28:31]
  ds_read_b64_tr_b16 v[124:125], v189 offset:40960
  v_mfma_f32_16x16x32_bf16 v[24:27], v[164:167], v[144:147], v[24:27]
  ds_read_b64_tr_b16 v[126:127], v189 offset:41472
  v_mfma_f32_16x16x32_bf16 v[40:43], v[144:147], v[168:171], v[40:43]
  ds_read_b64_tr_b16 v[128:129], v188 offset:49152
  v_mfma_f32_16x16x32_bf16 v[44:47], v[148:151], v[168:171], v[44:47]
  ds_read_b64_tr_b16 v[130:131], v188 offset:49664
  v_mfma_f32_16x16x32_bf16 v[48:51], v[152:155], v[168:171], v[48:51]
  ds_read_b64_tr_b16 v[132:133], v189 offset:49152
  v_mfma_f32_16x16x32_bf16 v[52:55], v[156:159], v[168:171], v[52:55]
  ds_read_b64_tr_b16 v[134:135], v189 offset:49664
  v_mfma_f32_16x16x32_bf16 v[68:71], v[156:159], v[172:175], v[68:71]
  ds_read_b64_tr_b16 v[136:137], v188 offset:57344
  v_mfma_f32_16x16x32_bf16 v[64:67], v[152:155], v[172:175], v[64:67]
  ds_read_b64_tr_b16 v[138:139], v188 offset:57856
  v_mfma_f32_16x16x32_bf16 v[60:63], v[148:151], v[172:175], v[60:63]
  ds_read_b64_tr_b16 v[140:141], v189 offset:57344
  v_mfma_f32_16x16x32_bf16 v[56:59], v[144:147], v[172:175], v[56:59]
  ds_read_b64_tr_b16 v[142:143], v189 offset:57856
  v_mfma_f32_16x16x32_bf16 v[72:75], v[144:147], v[176:179], v[72:75]
  v_mfma_f32_16x16x32_bf16 v[76:79], v[148:151], v[176:179], v[76:79]
  v_mfma_f32_16x16x32_bf16 v[80:83], v[152:155], v[176:179], v[80:83]
  v_mfma_f32_16x16x32_bf16 v[84:87], v[156:159], v[176:179], v[84:87]
  v_mfma_f32_16x16x32_bf16 v[100:103], v[156:159], v[180:183], v[100:103]
  v_mfma_f32_16x16x32_bf16 v[96:99], v[152:155], v[180:183], v[96:99]
  v_mfma_f32_16x16x32_bf16 v[92:95], v[148:151], v[180:183], v[92:95]
  v_mfma_f32_16x16x32_bf16 v[88:91], v[144:147], v[180:183], v[88:91]
  s_waitcnt lgkmcnt(0)
  v_mfma_f32_16x16x32_bf16 v[8:11], v[120:123], v[104:107], v[8:11]
  ds_read_b128 v[144:147], v185 offset:40960
  v_mfma_f32_16x16x32_bf16 v[12:15], v[120:123], v[108:111], v[12:15]
  ds_read_b64_tr_b16 v[160:161], v188 offset:45056
  v_mfma_f32_16x16x32_bf16 v[16:19], v[120:123], v[112:115], v[16:19]
  ds_read_b64_tr_b16 v[162:163], v188 offset:45568
  v_mfma_f32_16x16x32_bf16 v[20:23], v[120:123], v[116:119], v[20:23]
  ds_read_b128 v[148:151], v185 offset:43008
  v_mfma_f32_16x16x32_bf16 v[36:39], v[124:127], v[116:119], v[36:39]
  ds_read_b128 v[152:155], v185 offset:45056
  v_mfma_f32_16x16x32_bf16 v[32:35], v[124:127], v[112:115], v[32:35]
  ds_read_b128 v[156:159], v185 offset:47104
  v_mfma_f32_16x16x32_bf16 v[28:31], v[124:127], v[108:111], v[28:31]
  ds_read_b64_tr_b16 v[164:165], v189 offset:45056
  v_mfma_f32_16x16x32_bf16 v[24:27], v[124:127], v[104:107], v[24:27]
  ds_read_b64_tr_b16 v[166:167], v189 offset:45568
  v_mfma_f32_16x16x32_bf16 v[40:43], v[104:107], v[128:131], v[40:43]
  ds_read_b64_tr_b16 v[168:169], v188 offset:53248
  v_mfma_f32_16x16x32_bf16 v[44:47], v[108:111], v[128:131], v[44:47]
  ds_read_b64_tr_b16 v[170:171], v188 offset:53760
  v_mfma_f32_16x16x32_bf16 v[48:51], v[112:115], v[128:131], v[48:51]
  ds_read_b64_tr_b16 v[172:173], v189 offset:53248
  v_mfma_f32_16x16x32_bf16 v[52:55], v[116:119], v[128:131], v[52:55]
  ds_read_b64_tr_b16 v[174:175], v189 offset:53760
  v_mfma_f32_16x16x32_bf16 v[68:71], v[116:119], v[132:135], v[68:71]
  ds_read_b64_tr_b16 v[176:177], v188 offset:61440
  v_mfma_f32_16x16x32_bf16 v[64:67], v[112:115], v[132:135], v[64:67]
  ds_read_b64_tr_b16 v[178:179], v188 offset:61952
  v_mfma_f32_16x16x32_bf16 v[60:63], v[108:111], v[132:135], v[60:63]
  ds_read_b64_tr_b16 v[180:181], v189 offset:61440
  v_mfma_f32_16x16x32_bf16 v[56:59], v[104:107], v[132:135], v[56:59]
  ds_read_b64_tr_b16 v[182:183], v189 offset:61952
  v_mfma_f32_16x16x32_bf16 v[72:75], v[104:107], v[136:139], v[72:75]
  v_mfma_f32_16x16x32_bf16 v[76:79], v[108:111], v[136:139], v[76:79]
  v_mfma_f32_16x16x32_bf16 v[80:83], v[112:115], v[136:139], v[80:83]
  v_mfma_f32_16x16x32_bf16 v[84:87], v[116:119], v[136:139], v[84:87]
  v_mfma_f32_16x16x32_bf16 v[100:103], v[116:119], v[140:143], v[100:103]
  v_mfma_f32_16x16x32_bf16 v[96:99], v[112:115], v[140:143], v[96:99]
  v_mfma_f32_16x16x32_bf16 v[92:95], v[108:111], v[140:143], v[92:95]
  v_mfma_f32_16x16x32_bf16 v[88:91], v[104:107], v[140:143], v[88:91]
  s_cmp_lg_u32 s24, 0
  s_cbranch_scc1 L_noup_18
  ds_read_b64 v[220:221], v210 offset:0
  s_lshr_b32 s98, s29, 4
  s_lshl_b32 s98, s98, 8
  s_add_u32 s98, s98, 13643776
  v_and_b32 v213, 15, v0
  v_lshlrev_b32 v213, 3, v213
  buffer_load_dwordx2 v[216:217], v213, s[12:15], s98 offen sc1
L_noup_18:
  s_waitcnt lgkmcnt(0)
  s_barrier
  v_mfma_f32_16x16x32_bf16 v[8:11], v[160:163], v[144:147], v[8:11]
  ds_read_b128 v[104:107], v186 offset:0
  v_mfma_f32_16x16x32_bf16 v[12:15], v[160:163], v[148:151], v[12:15]
  ds_read_b64_tr_b16 v[120:121], v190 offset:0
  v_mfma_f32_16x16x32_bf16 v[16:19], v[160:163], v[152:155], v[16:19]
  ds_read_b64_tr_b16 v[122:123], v190 offset:512
  v_mfma_f32_16x16x32_bf16 v[20:23], v[160:163], v[156:159], v[20:23]
  ds_read_b128 v[108:111], v186 offset:2048
  v_mfma_f32_16x16x32_bf16 v[36:39], v[164:167], v[156:159], v[36:39]
  ds_read_b128 v[112:115], v186 offset:4096
  v_mfma_f32_16x16x32_bf16 v[32:35], v[164:167], v[152:155], v[32:35]
  ds_read_b128 v[116:119], v186 offset:6144
  v_mfma_f32_16x16x32_bf16 v[28:31], v[164:167], v[148:151], v[28:31]
  ds_read_b64_tr_b16 v[124:125], v191 offset:0
  v_mfma_f32_16x16x32_bf16 v[24:27], v[164:167], v[144:147], v[24:27]
  ds_read_b64_tr_b16 v[126:127], v191 offset:512
  v_mfma_f32_16x16x32_bf16 v[40:43], v[144:147], v[168:171], v[40:43]
  ds_read_b64_tr_b16 v[128:129], v190 offset:8192
  v_mfma_f32_16x16x32_bf16 v[44:47], v[148:151], v[168:171], v[44:47]
  ds_read_b64_tr_b16 v[130:131], v190 offset:8704
  v_mfma_f32_16x16x32_bf16 v[48:51], v[152:155], v[168:171], v[48:51]
  ds_read_b64_tr_b16 v[132:133], v191 offset:8192
  v_mfma_f32_16x16x32_bf16 v[52:55], v[156:159], v[168:171], v[52:55]
  ds_read_b64_tr_b16 v[134:135], v191 offset:8704
  v_mfma_f32_16x16x32_bf16 v[68:71], v[156:159], v[172:175], v[68:71]
  ds_read_b64_tr_b16 v[136:137], v190 offset:16384
  v_mfma_f32_16x16x32_bf16 v[64:67], v[152:155], v[172:175], v[64:67]
  ds_read_b64_tr_b16 v[138:139], v190 offset:16896
  v_mfma_f32_16x16x32_bf16 v[60:63], v[148:151], v[172:175], v[60:63]
  ds_read_b64_tr_b16 v[140:141], v191 offset:16384
  v_mfma_f32_16x16x32_bf16 v[56:59], v[144:147], v[172:175], v[56:59]
  ds_read_b64_tr_b16 v[142:143], v191 offset:16896
  v_mfma_f32_16x16x32_bf16 v[72:75], v[144:147], v[176:179], v[72:75]
  v_mfma_f32_16x16x32_bf16 v[76:79], v[148:151], v[176:179], v[76:79]
  v_mfma_f32_16x16x32_bf16 v[80:83], v[152:155], v[176:179], v[80:83]
  v_mfma_f32_16x16x32_bf16 v[84:87], v[156:159], v[176:179], v[84:87]
  v_mfma_f32_16x16x32_bf16 v[100:103], v[156:159], v[180:183], v[100:103]
  v_mfma_f32_16x16x32_bf16 v[96:99], v[152:155], v[180:183], v[96:99]
  v_mfma_f32_16x16x32_bf16 v[92:95], v[148:151], v[180:183], v[92:95]
  v_mfma_f32_16x16x32_bf16 v[88:91], v[144:147], v[180:183], v[88:91]
  s_waitcnt lgkmcnt(0)
  v_mfma_f32_16x16x32_bf16 v[8:11], v[120:123], v[104:107], v[8:11]
  ds_read_b128 v[144:147], v187 offset:0
  v_mfma_f32_16x16x32_bf16 v[12:15], v[120:123], v[108:111], v[12:15]
  ds_read_b64_tr_b16 v[160:161], v190 offset:4096
  v_mfma_f32_16x16x32_bf16 v[16:19], v[120:123], v[112:115], v[16:19]
  ds_read_b64_tr_b16 v[162:163], v190 offset:4608
  v_mfma_f32_16x16x32_bf16 v[20:23], v[120:123], v[116:119], v[20:23]
  ds_read_b128 v[148:151], v187 offset:2048
  v_mfma_f32_16x16x32_bf16 v[36:39], v[124:127], v[116:119], v[36:39]
  ds_read_b128 v[152:155], v187 offset:4096
  v_mfma_f32_16x16x32_bf16 v[32:35], v[124:127], v[112:115], v[32:35]
  ds_read_b128 v[156:159], v187 offset:6144
  v_mfma_f32_16x16x32_bf16 v[28:31], v[124:127], v[108:111], v[28:31]
  ds_read_b64_tr_b16 v[164:165], v191 offset:4096
  v_mfma_f32_16x16x32_bf16 v[24:27], v[124:127], v[104:107], v[24:27]
  ds_read_b64_tr_b16 v[166:167], v191 offset:4608
  v_mfma_f32_16x16x32_bf16 v[40:43], v[104:107], v[128:131], v[40:43]
  ds_read_b64_tr_b16 v[168:169], v190 offset:12288
  v_mfma_f32_16x16x32_bf16 v[44:47], v[108:111], v[128:131], v[44:47]
  ds_read_b64_tr_b16 v[170:171], v190 offset:12800
  v_mfma_f32_16x16x32_bf16 v[48:51], v[112:115], v[128:131], v[48:51]
  ds_read_b64_tr_b16 v[172:173], v191 offset:12288
  v_mfma_f32_16x16x32_bf16 v[52:55], v[116:119], v[128:131], v[52:55]
  ds_read_b64_tr_b16 v[174:175], v191 offset:12800
  v_mfma_f32_16x16x32_bf16 v[68:71], v[116:119], v[132:135], v[68:71]
  ds_read_b64_tr_b16 v[176:177], v190 offset:20480
  v_mfma_f32_16x16x32_bf16 v[64:67], v[112:115], v[132:135], v[64:67]
  ds_read_b64_tr_b16 v[178:179], v190 offset:20992
  v_mfma_f32_16x16x32_bf16 v[60:63], v[108:111], v[132:135], v[60:63]
  ds_read_b64_tr_b16 v[180:181], v191 offset:20480
  v_mfma_f32_16x16x32_bf16 v[56:59], v[104:107], v[132:135], v[56:59]
  ds_read_b64_tr_b16 v[182:183], v191 offset:20992
  v_mfma_f32_16x16x32_bf16 v[72:75], v[104:107], v[136:139], v[72:75]
  v_mfma_f32_16x16x32_bf16 v[76:79], v[108:111], v[136:139], v[76:79]
  v_mfma_f32_16x16x32_bf16 v[80:83], v[112:115], v[136:139], v[80:83]
  v_mfma_f32_16x16x32_bf16 v[84:87], v[116:119], v[136:139], v[84:87]
  v_mfma_f32_16x16x32_bf16 v[100:103], v[116:119], v[140:143], v[100:103]
  v_mfma_f32_16x16x32_bf16 v[96:99], v[112:115], v[140:143], v[96:99]
  v_mfma_f32_16x16x32_bf16 v[92:95], v[108:111], v[140:143], v[92:95]
  v_mfma_f32_16x16x32_bf16 v[88:91], v[104:107], v[140:143], v[88:91]
  s_waitcnt lgkmcnt(0)
  s_barrier
  v_mfma_f32_16x16x32_bf16 v[8:11], v[160:163], v[144:147], v[8:11]
  ds_read_b128 v[104:107], v184 offset:0
  v_mfma_f32_16x16x32_bf16 v[12:15], v[160:163], v[148:151], v[12:15]
  ds_read_b64_tr_b16 v[120:121], v188 offset:0
  v_mfma_f32_16x16x32_bf16 v[16:19], v[160:163], v[152:155], v[16:19]
  ds_read_b64_tr_b16 v[122:123], v188 offset:512
  v_mfma_f32_16x16x32_bf16 v[20:23], v[160:163], v[156:159], v[20:23]
  ds_read_b128 v[108:111], v184 offset:2048
  v_mfma_f32_16x16x32_bf16 v[36:39], v[164:167], v[156:159], v[36:39]
  ds_read_b128 v[112:115], v184 offset:4096
  v_mfma_f32_16x16x32_bf16 v[32:35], v[164:167], v[152:155], v[32:35]
  ds_read_b128 v[116:119], v184 offset:6144
  v_mfma_f32_16x16x32_bf16 v[28:31], v[164:167], v[148:151], v[28:31]
  ds_read_b64_tr_b16 v[124:125], v189 offset:0
  v_mfma_f32_16x16x32_bf16 v[24:27], v[164:167], v[144:147], v[24:27]
  ds_read_b64_tr_b16 v[126:127], v189 offset:512
  v_mfma_f32_16x16x32_bf16 v[40:43], v[144:147], v[168:171], v[40:43]
  ds_read_b64_tr_b16 v[128:129], v188 offset:8192
  v_mfma_f32_16x16x32_bf16 v[44:47], v[148:151], v[168:171], v[44:47]
  ds_read_b64_tr_b16 v[130:131], v188 offset:8704
  v_mfma_f32_16x16x32_bf16 v[48:51], v[152:155], v[168:171], v[48:51]
  ds_read_b64_tr_b16 v[132:133], v189 offset:8192
  v_mfma_f32_16x16x32_bf16 v[52:55], v[156:159], v[168:171], v[52:55]
  ds_read_b64_tr_b16 v[134:135], v189 offset:8704
  v_mfma_f32_16x16x32_bf16 v[68:71], v[156:159], v[172:175], v[68:71]
  ds_read_b64_tr_b16 v[136:137], v188 offset:16384
  v_mfma_f32_16x16x32_bf16 v[64:67], v[152:155], v[172:175], v[64:67]
  ds_read_b64_tr_b16 v[138:139], v188 offset:16896
  v_mfma_f32_16x16x32_bf16 v[60:63], v[148:151], v[172:175], v[60:63]
  ds_read_b64_tr_b16 v[140:141], v189 offset:16384
  v_mfma_f32_16x16x32_bf16 v[56:59], v[144:147], v[172:175], v[56:59]
  ds_read_b64_tr_b16 v[142:143], v189 offset:16896
  v_mfma_f32_16x16x32_bf16 v[72:75], v[144:147], v[176:179], v[72:75]
  v_mfma_f32_16x16x32_bf16 v[76:79], v[148:151], v[176:179], v[76:79]
  v_mfma_f32_16x16x32_bf16 v[80:83], v[152:155], v[176:179], v[80:83]
  v_mfma_f32_16x16x32_bf16 v[84:87], v[156:159], v[176:179], v[84:87]
  v_mfma_f32_16x16x32_bf16 v[100:103], v[156:159], v[180:183], v[100:103]
  v_mfma_f32_16x16x32_bf16 v[96:99], v[152:155], v[180:183], v[96:99]
  v_mfma_f32_16x16x32_bf16 v[92:95], v[148:151], v[180:183], v[92:95]
  v_mfma_f32_16x16x32_bf16 v[88:91], v[144:147], v[180:183], v[88:91]
  s_waitcnt lgkmcnt(0)
  v_mfma_f32_16x16x32_bf16 v[8:11], v[120:123], v[104:107], v[8:11]
  ds_read_b128 v[144:147], v185 offset:0
  v_mfma_f32_16x16x32_bf16 v[12:15], v[120:123], v[108:111], v[12:15]
  ds_read_b64_tr_b16 v[160:161], v188 offset:4096
  v_mfma_f32_16x16x32_bf16 v[16:19], v[120:123], v[112:115], v[16:19]
  ds_read_b64_tr_b16 v[162:163], v188 offset:4608
  v_mfma_f32_16x16x32_bf16 v[20:23], v[120:123], v[116:119], v[20:23]
  ds_read_b128 v[148:151], v185 offset:2048
  v_mfma_f32_16x16x32_bf16 v[36:39], v[124:127], v[116:119], v[36:39]
  ds_read_b128 v[152:155], v185 offset:4096
  v_mfma_f32_16x16x32_bf16 v[32:35], v[124:127], v[112:115], v[32:35]
  ds_read_b128 v[156:159], v185 offset:6144
  v_mfma_f32_16x16x32_bf16 v[28:31], v[124:127], v[108:111], v[28:31]
  ds_read_b64_tr_b16 v[164:165], v189 offset:4096
  v_mfma_f32_16x16x32_bf16 v[24:27], v[124:127], v[104:107], v[24:27]
  ds_read_b64_tr_b16 v[166:167], v189 offset:4608
  v_mfma_f32_16x16x32_bf16 v[40:43], v[104:107], v[128:131], v[40:43]
  ds_read_b64_tr_b16 v[168:169], v188 offset:12288
  v_mfma_f32_16x16x32_bf16 v[44:47], v[108:111], v[128:131], v[44:47]
  ds_read_b64_tr_b16 v[170:171], v188 offset:12800
  v_mfma_f32_16x16x32_bf16 v[48:51], v[112:115], v[128:131], v[48:51]
  ds_read_b64_tr_b16 v[172:173], v189 offset:12288
  v_mfma_f32_16x16x32_bf16 v[52:55], v[116:119], v[128:131], v[52:55]
  ds_read_b64_tr_b16 v[174:175], v189 offset:12800
  v_mfma_f32_16x16x32_bf16 v[68:71], v[116:119], v[132:135], v[68:71]
  ds_read_b64_tr_b16 v[176:177], v188 offset:20480
  v_mfma_f32_16x16x32_bf16 v[64:67], v[112:115], v[132:135], v[64:67]
  ds_read_b64_tr_b16 v[178:179], v188 offset:20992
  v_mfma_f32_16x16x32_bf16 v[60:63], v[108:111], v[132:135], v[60:63]
  ds_read_b64_tr_b16 v[180:181], v189 offset:20480
  v_mfma_f32_16x16x32_bf16 v[56:59], v[104:107], v[132:135], v[56:59]
  ds_read_b64_tr_b16 v[182:183], v189 offset:20992
  v_mfma_f32_16x16x32_bf16 v[72:75], v[104:107], v[136:139], v[72:75]
  v_mfma_f32_16x16x32_bf16 v[76:79], v[108:111], v[136:139], v[76:79]
  v_mfma_f32_16x16x32_bf16 v[80:83], v[112:115], v[136:139], v[80:83]
  v_mfma_f32_16x16x32_bf16 v[84:87], v[116:119], v[136:139], v[84:87]
  v_mfma_f32_16x16x32_bf16 v[100:103], v[116:119], v[140:143], v[100:103]
  v_mfma_f32_16x16x32_bf16 v[96:99], v[112:115], v[140:143], v[96:99]
  v_mfma_f32_16x16x32_bf16 v[92:95], v[108:111], v[140:143], v[92:95]
  v_mfma_f32_16x16x32_bf16 v[88:91], v[104:107], v[140:143], v[88:91]
  s_cmp_lg_u32 s24, 0
  s_cbranch_scc1 L_noup_19
  s_mov_b32 s58, 0
L_upoll_20:
  s_waitcnt vmcnt(0)
  v_cmp_ne_u64 vcc, v[220:221], v[216:217]
  s_add_u32 s58, s58, 1
  s_cmp_ge_u32 s58, 4194304
  s_cbranch_scc1 L_noup_19
  s_nop 3
  s_cbranch_vccz L_noup_19
  buffer_load_dwordx2 v[216:217], v213, s[12:15], s98 offen sc1
  s_branch L_upoll_20
L_noup_19:
  s_waitcnt lgkmcnt(0)
  s_barrier
  v_mfma_f32_16x16x32_bf16 v[8:11], v[160:163], v[144:147], v[8:11]
  ds_read_b128 v[104:107], v184 offset:40960
  v_mfma_f32_16x16x32_bf16 v[12:15], v[160:163], v[148:151], v[12:15]
  ds_read_b64_tr_b16 v[120:121], v188 offset:40960
  v_mfma_f32_16x16x32_bf16 v[16:19], v[160:163], v[152:155], v[16:19]
  ds_read_b64_tr_b16 v[122:123], v188 offset:41472
  v_mfma_f32_16x16x32_bf16 v[20:23], v[160:163], v[156:159], v[20:23]
  ds_read_b128 v[108:111], v184 offset:43008
  v_mfma_f32_16x16x32_bf16 v[36:39], v[164:167], v[156:159], v[36:39]
  ds_read_b128 v[112:115], v184 offset:45056
  v_mfma_f32_16x16x32_bf16 v[32:35], v[164:167], v[152:155], v[32:35]
  ds_read_b128 v[116:119], v184 offset:47104
  v_mfma_f32_16x16x32_bf16 v[28:31], v[164:167], v[148:151], v[28:31]
  ds_read_b64_tr_b16 v[124:125], v189 offset:40960
  v_mfma_f32_16x16x32_bf16 v[24:27], v[164:167], v[144:147], v[24:27]
  ds_read_b64_tr_b16 v[126:127], v189 offset:41472
  v_mfma_f32_16x16x32_bf16 v[40:43], v[144:147], v[168:171], v[40:43]
  ds_read_b64_tr_b16 v[128:129], v188 offset:49152
  v_mfma_f32_16x16x32_bf16 v[44:47], v[148:151], v[168:171], v[44:47]
  ds_read_b64_tr_b16 v[130:131], v188 offset:49664
  v_mfma_f32_16x16x32_bf16 v[48:51], v[152:155], v[168:171], v[48:51]
  ds_read_b64_tr_b16 v[132:133], v189 offset:49152
  v_mfma_f32_16x16x32_bf16 v[52:55], v[156:159], v[168:171], v[52:55]
  ds_read_b64_tr_b16 v[134:135], v189 offset:49664
  v_mfma_f32_16x16x32_bf16 v[68:71], v[156:159], v[172:175], v[68:71]
  ds_read_b64_tr_b16 v[136:137], v188 offset:57344
  v_mfma_f32_16x16x32_bf16 v[64:67], v[152:155], v[172:175], v[64:67]
  ds_read_b64_tr_b16 v[138:139], v188 offset:57856
  v_mfma_f32_16x16x32_bf16 v[60:63], v[148:151], v[172:175], v[60:63]
  ds_read_b64_tr_b16 v[140:141], v189 offset:57344
  v_mfma_f32_16x16x32_bf16 v[56:59], v[144:147], v[172:175], v[56:59]
  ds_read_b64_tr_b16 v[142:143], v189 offset:57856
  v_mfma_f32_16x16x32_bf16 v[72:75], v[144:147], v[176:179], v[72:75]
  v_mfma_f32_16x16x32_bf16 v[76:79], v[148:151], v[176:179], v[76:79]
  v_mfma_f32_16x16x32_bf16 v[80:83], v[152:155], v[176:179], v[80:83]
  v_mfma_f32_16x16x32_bf16 v[84:87], v[156:159], v[176:179], v[84:87]
  v_mfma_f32_16x16x32_bf16 v[100:103], v[156:159], v[180:183], v[100:103]
  v_mfma_f32_16x16x32_bf16 v[96:99], v[152:155], v[180:183], v[96:99]
  v_mfma_f32_16x16x32_bf16 v[92:95], v[148:151], v[180:183], v[92:95]
  v_mfma_f32_16x16x32_bf16 v[88:91], v[144:147], v[180:183], v[88:91]
  s_waitcnt lgkmcnt(0)
  v_mfma_f32_16x16x32_bf16 v[8:11], v[120:123], v[104:107], v[8:11]
  ds_read_b128 v[144:147], v185 offset:40960
  v_mfma_f32_16x16x32_bf16 v[12:15], v[120:123], v[108:111], v[12:15]
  ds_read_b64_tr_b16 v[160:161], v188 offset:45056
  v_mfma_f32_16x16x32_bf16 v[16:19], v[120:123], v[112:115], v[16:19]
  ds_read_b64_tr_b16 v[162:163], v188 offset:45568
  v_mfma_f32_16x16x32_bf16 v[20:23], v[120:123], v[116:119], v[20:23]
  ds_read_b128 v[148:151], v185 offset:43008
  v_mfma_f32_16x16x32_bf16 v[36:39], v[124:127], v[116:119], v[36:39]
  ds_read_b128 v[152:155], v185 offset:45056
  v_mfma_f32_16x16x32_bf16 v[32:35], v[124:127], v[112:115], v[32:35]
  ds_read_b128 v[156:159], v185 offset:47104
  v_mfma_f32_16x16x32_bf16 v[28:31], v[124:127], v[108:111], v[28:31]
  ds_read_b64_tr_b16 v[164:165], v189 offset:45056
  v_mfma_f32_16x16x32_bf16 v[24:27], v[124:127], v[104:107], v[24:27]
  ds_read_b64_tr_b16 v[166:167], v189 offset:45568
  v_mfma_f32_16x16x32_bf16 v[40:43], v[104:107], v[128:131], v[40:43]
  ds_read_b64_tr_b16 v[168:169], v188 offset:53248
  v_mfma_f32_16x16x32_bf16 v[44:47], v[108:111], v[128:131], v[44:47]
  ds_read_b64_tr_b16 v[170:171], v188 offset:53760
  v_mfma_f32_16x16x32_bf16 v[48:51], v[112:115], v[128:131], v[48:51]
  ds_read_b64_tr_b16 v[172:173], v189 offset:53248
  v_mfma_f32_16x16x32_bf16 v[52:55], v[116:119], v[128:131], v[52:55]
  ds_read_b64_tr_b16 v[174:175], v189 offset:53760
  v_mfma_f32_16x16x32_bf16 v[68:71], v[116:119], v[132:135], v[68:71]
  ds_read_b64_tr_b16 v[176:177], v188 offset:61440
  v_mfma_f32_16x16x32_bf16 v[64:67], v[112:115], v[132:135], v[64:67]
  ds_read_b64_tr_b16 v[178:179], v188 offset:61952
  v_mfma_f32_16x16x32_bf16 v[60:63], v[108:111], v[132:135], v[60:63]
  ds_read_b64_tr_b16 v[180:181], v189 offset:61440
  v_mfma_f32_16x16x32_bf16 v[56:59], v[104:107], v[132:135], v[56:59]
  ds_read_b64_tr_b16 v[182:183], v189 offset:61952
  v_mfma_f32_16x16x32_bf16 v[72:75], v[104:107], v[136:139], v[72:75]
  v_mfma_f32_16x16x32_bf16 v[76:79], v[108:111], v[136:139], v[76:79]
  v_mfma_f32_16x16x32_bf16 v[80:83], v[112:115], v[136:139], v[80:83]
  v_mfma_f32_16x16x32_bf16 v[84:87], v[116:119], v[136:139], v[84:87]
  v_mfma_f32_16x16x32_bf16 v[100:103], v[116:119], v[140:143], v[100:103]
  v_mfma_f32_16x16x32_bf16 v[96:99], v[112:115], v[140:143], v[96:99]
  v_mfma_f32_16x16x32_bf16 v[92:95], v[108:111], v[140:143], v[92:95]
  v_mfma_f32_16x16x32_bf16 v[88:91], v[104:107], v[140:143], v[88:91]
  s_waitcnt lgkmcnt(0)
  s_barrier
  v_mfma_f32_16x16x32_bf16 v[8:11], v[160:163], v[144:147], v[8:11]
  ds_read_b128 v[104:107], v186 offset:0
  v_mfma_f32_16x16x32_bf16 v[12:15], v[160:163], v[148:151], v[12:15]
  ds_read_b64_tr_b16 v[120:121], v190 offset:0
  v_mfma_f32_16x16x32_bf16 v[16:19], v[160:163], v[152:155], v[16:19]
  ds_read_b64_tr_b16 v[122:123], v190 offset:512
  v_mfma_f32_16x16x32_bf16 v[20:23], v[160:163], v[156:159], v[20:23]
  ds_read_b128 v[108:111], v186 offset:2048
  v_mfma_f32_16x16x32_bf16 v[36:39], v[164:167], v[156:159], v[36:39]
  ds_read_b128 v[112:115], v186 offset:4096
  v_mfma_f32_16x16x32_bf16 v[32:35], v[164:167], v[152:155], v[32:35]
  ds_read_b128 v[116:119], v186 offset:6144
  v_mfma_f32_16x16x32_bf16 v[28:31], v[164:167], v[148:151], v[28:31]
  ds_read_b64_tr_b16 v[124:125], v191 offset:0
  v_mfma_f32_16x16x32_bf16 v[24:27], v[164:167], v[144:147], v[24:27]
  ds_read_b64_tr_b16 v[126:127], v191 offset:512
  v_mfma_f32_16x16x32_bf16 v[40:43], v[144:147], v[168:171], v[40:43]
  ds_read_b64_tr_b16 v[128:129], v190 offset:8192
  v_mfma_f32_16x16x32_bf16 v[44:47], v[148:151], v[168:171], v[44:47]
  ds_read_b64_tr_b16 v[130:131], v190 offset:8704
  v_mfma_f32_16x16x32_bf16 v[48:51], v[152:155], v[168:171], v[48:51]
  ds_read_b64_tr_b16 v[132:133], v191 offset:8192
  v_mfma_f32_16x16x32_bf16 v[52:55], v[156:159], v[168:171], v[52:55]
  ds_read_b64_tr_b16 v[134:135], v191 offset:8704
  v_mfma_f32_16x16x32_bf16 v[68:71], v[156:159], v[172:175], v[68:71]
  ds_read_b64_tr_b16 v[136:137], v190 offset:16384
  v_mfma_f32_16x16x32_bf16 v[64:67], v[152:155], v[172:175], v[64:67]
  ds_read_b64_tr_b16 v[138:139], v190 offset:16896
  v_mfma_f32_16x16x32_bf16 v[60:63], v[148:151], v[172:175], v[60:63]
  ds_read_b64_tr_b16 v[140:141], v191 offset:16384
  v_mfma_f32_16x16x32_bf16 v[56:59], v[144:147], v[172:175], v[56:59]
  ds_read_b64_tr_b16 v[142:143], v191 offset:16896
  v_mfma_f32_16x16x32_bf16 v[72:75], v[144:147], v[176:179], v[72:75]
  v_mfma_f32_16x16x32_bf16 v[76:79], v[148:151], v[176:179], v[76:79]
  v_mfma_f32_16x16x32_bf16 v[80:83], v[152:155], v[176:179], v[80:83]
  v_mfma_f32_16x16x32_bf16 v[84:87], v[156:159], v[176:179], v[84:87]
  v_mfma_f32_16x16x32_bf16 v[100:103], v[156:159], v[180:183], v[100:103]
  v_mfma_f32_16x16x32_bf16 v[96:99], v[152:155], v[180:183], v[96:99]
  v_mfma_f32_16x16x32_bf16 v[92:95], v[148:151], v[180:183], v[92:95]
  v_mfma_f32_16x16x32_bf16 v[88:91], v[144:147], v[180:183], v[88:91]
  s_waitcnt lgkmcnt(0)
  v_mfma_f32_16x16x32_bf16 v[40:43], v[104:107], v[128:131], v[40:43]
  ds_read_b128 v[144:147], v187 offset:0
  v_mfma_f32_16x16x32_bf16 v[44:47], v[108:111], v[128:131], v[44:47]
  ds_read_b64_tr_b16 v[160:161], v190 offset:4096
  v_mfma_f32_16x16x32_bf16 v[48:51], v[112:115], v[128:131], v[48:51]
  ds_read_b64_tr_b16 v[162:163], v190 offset:4608
  v_mfma_f32_16x16x32_bf16 v[52:55], v[116:119], v[128:131], v[52:55]
  ds_read_b128 v[148:151], v187 offset:2048
  v_mfma_f32_16x16x32_bf16 v[68:71], v[116:119], v[132:135], v[68:71]
  ds_read_b128 v[152:155], v187 offset:4096
  v_mfma_f32_16x16x32_bf16 v[64:67], v[112:115], v[132:135], v[64:67]
  ds_read_b128 v[156:159], v187 offset:6144
  v_mfma_f32_16x16x32_bf16 v[60:63], v[108:111], v[132:135], v[60:63]
  ds_read_b64_tr_b16 v[164:165], v191 offset:4096
  v_mfma_f32_16x16x32_bf16 v[56:59], v[104:107], v[132:135], v[56:59]
  ds_read_b64_tr_b16 v[166:167], v191 offset:4608
  v_mfma_f32_16x16x32_bf16 v[72:75], v[104:107], v[136:139], v[72:75]
  ds_read_b64_tr_b16 v[168:169], v190 offset:12288
  v_mfma_f32_16x16x32_bf16 v[76:79], v[108:111], v[136:139], v[76:79]
  ds_read_b64_tr_b16 v[170:171], v190 offset:12800
  v_mfma_f32_16x16x32_bf16 v[80:83], v[112:115], v[136:139], v[80:83]
  ds_read_b64_tr_b16 v[172:173], v191 offset:12288
  v_mfma_f32_16x16x32_bf16 v[84:87], v[116:119], v[136:139], v[84:87]
  ds_read_b64_tr_b16 v[174:175], v191 offset:12800
  v_mfma_f32_16x16x32_bf16 v[100:103], v[116:119], v[140:143], v[100:103]
  ds_read_b64_tr_b16 v[176:177], v190 offset:20480
  v_mfma_f32_16x16x32_bf16 v[96:99], v[112:115], v[140:143], v[96:99]
  ds_read_b64_tr_b16 v[178:179], v190 offset:20992
  v_mfma_f32_16x16x32_bf16 v[92:95], v[108:111], v[140:143], v[92:95]
  ds_read_b64_tr_b16 v[180:181], v191 offset:20480
  v_mfma_f32_16x16x32_bf16 v[88:91], v[104:107], v[140:143], v[88:91]
  ds_read_b64_tr_b16 v[182:183], v191 offset:20992
  s_waitcnt lgkmcnt(0)
  s_barrier
  v_mfma_f32_16x16x32_bf16 v[40:43], v[144:147], v[168:171], v[40:43]
  v_mfma_f32_16x16x32_bf16 v[44:47], v[148:151], v[168:171], v[44:47]
  v_mfma_f32_16x16x32_bf16 v[48:51], v[152:155], v[168:171], v[48:51]
  v_mfma_f32_16x16x32_bf16 v[52:55], v[156:159], v[168:171], v[52:55]
  v_mfma_f32_16x16x32_bf16 v[68:71], v[156:159], v[172:175], v[68:71]
  v_mfma_f32_16x16x32_bf16 v[64:67], v[152:155], v[172:175], v[64:67]
  v_mfma_f32_16x16x32_bf16 v[60:63], v[148:151], v[172:175], v[60:63]
  v_mfma_f32_16x16x32_bf16 v[56:59], v[144:147], v[172:175], v[56:59]
  v_mfma_f32_16x16x32_bf16 v[72:75], v[144:147], v[176:179], v[72:75]
  v_mfma_f32_16x16x32_bf16 v[76:79], v[148:151], v[176:179], v[76:79]
  v_mul_f32 v228, s56, v40
  v_mul_f32 v229, s56, v41
  v_mul_f32 v230, s56, v42
  v_mul_f32 v231, s56, v43
  v_exp_f32_e64 v228, v228 clamp
  v_exp_f32_e64 v229, v229 clamp
  v_exp_f32_e64 v230, v230 clamp
  v_exp_f32_e64 v231, v231 clamp
  v_max_f32 v40, s36, v40
  v_max_f32 v41, s36, v41
  v_mfma_f32_16x16x32_bf16 v[80:83], v[152:155], v[176:179], v[80:83]
  v_max_f32 v42, s36, v42
  v_max_f32 v43, s36, v43
  v_add_f32 v228, v228, v40
  v_add_f32 v229, v229, v41
  v_add_f32 v230, v230, v42
  v_add_f32 v231, v231, v43
  v_cvt_pk_bf16_f32 v192, v228, v229
  v_cvt_pk_bf16_f32 v193, v230, v231
  v_mul_f32 v228, s56, v44
  v_mul_f32 v229, s56, v45
  v_mfma_f32_16x16x32_bf16 v[84:87], v[156:159], v[176:179], v[84:87]
  v_mul_f32 v230, s56, v46
  v_mul_f32 v231, s56, v47
  v_exp_f32_e64 v228, v228 clamp
  v_exp_f32_e64 v229, v229 clamp
  v_exp_f32_e64 v230, v230 clamp
  v_exp_f32_e64 v231, v231 clamp
  v_max_f32 v44, s36, v44
  v_max_f32 v45, s36, v45
  v_max_f32 v46, s36, v46
  v_max_f32 v47, s36, v47
  v_mfma_f32_16x16x32_bf16 v[100:103], v[156:159], v[180:183], v[100:103]
  v_add_f32 v228, v228, v44
  v_add_f32 v229, v229, v45
  v_add_f32 v230, v230, v46
  v_add_f32 v231, v231, v47
  v_cvt_pk_bf16_f32 v194, v228, v229
  v_cvt_pk_bf16_f32 v195, v230, v231
  v_mul_f32 v228, s56, v48
  v_mul_f32 v229, s56, v49
  v_mul_f32 v230, s56, v50
  v_mul_f32 v231, s56, v51
  v_mfma_f32_16x16x32_bf16 v[96:99], v[152:155], v[180:183], v[96:99]
  v_exp_f32_e64 v228, v228 clamp
  v_exp_f32_e64 v229, v229 clamp
  v_exp_f32_e64 v230, v230 clamp
  v_exp_f32_e64 v231, v231 clamp
  v_max_f32 v48, s36, v48
  v_max_f32 v49, s36, v49
  v_max_f32 v50, s36, v50
  v_max_f32 v51, s36, v51
  v_add_f32 v228, v228, v48
  v_add_f32 v229, v229, v49
  v_mfma_f32_16x16x32_bf16 v[92:95], v[148:151], v[180:183], v[92:95]
  v_add_f32 v230, v230, v50
  v_add_f32 v231, v231, v51
  v_cvt_pk_bf16_f32 v196, v228, v229
  v_cvt_pk_bf16_f32 v197, v230, v231
  v_mul_f32 v228, s56, v52
  v_mul_f32 v229, s56, v53
  v_mul_f32 v230, s56, v54
  v_mul_f32 v231, s56, v55
  v_exp_f32_e64 v228, v228 clamp
  v_exp_f32_e64 v229, v229 clamp
  v_mfma_f32_16x16x32_bf16 v[88:91], v[144:147], v[180:183], v[88:91]
  v_exp_f32_e64 v230, v230 clamp
  v_exp_f32_e64 v231, v231 clamp
  v_max_f32 v52, s36, v52
  v_max_f32 v53, s36, v53
  v_max_f32 v54, s36, v54
  v_max_f32 v55, s36, v55
  v_add_f32 v228, v228, v52
  v_add_f32 v229, v229, v53
  v_add_f32 v230, v230, v54
  v_add_f32 v231, v231, v55
  v_cvt_pk_bf16_f32 v198, v228, v229
  v_cvt_pk_bf16_f32 v199, v230, v231
  v_mul_f32 v228, s56, v56
  v_mul_f32 v229, s56, v57
  v_mul_f32 v230, s56, v58
  v_mul_f32 v231, s56, v59
  v_exp_f32_e64 v228, v228 clamp
  v_exp_f32_e64 v229, v229 clamp
  v_exp_f32_e64 v230, v230 clamp
  v_exp_f32_e64 v231, v231 clamp
  v_max_f32 v56, s36, v56
  v_max_f32 v57, s36, v57
  v_max_f32 v58, s36, v58
  v_max_f32 v59, s36, v59
  v_add_f32 v228, v228, v56
  v_add_f32 v229, v229, v57
  v_add_f32 v230, v230, v58
  v_add_f32 v231, v231, v59
  v_cvt_pk_bf16_f32 v200, v228, v229
  v_cvt_pk_bf16_f32 v201, v230, v231
  v_mul_f32 v228, s56, v60
  v_mul_f32 v229, s56, v61
  v_mul_f32 v230, s56, v62
  v_mul_f32 v231, s56, v63
  v_exp_f32_e64 v228, v228 clamp
  v_exp_f32_e64 v229, v229 clamp
  v_exp_f32_e64 v230, v230 clamp
  v_exp_f32_e64 v231, v231 clamp
  v_max_f32 v60, s36, v60
  v_max_f32 v61, s36, v61
  v_max_f32 v62, s36, v62
  v_max_f32 v63, s36, v63
  v_add_f32 v228, v228, v60
  v_add_f32 v229, v229, v61
  v_add_f32 v230, v230, v62
  v_add_f32 v231, v231, v63
  v_cvt_pk_bf16_f32 v202, v228, v229
  v_cvt_pk_bf16_f32 v203, v230, v231
  v_mul_f32 v228, s56, v64
  v_mul_f32 v229, s56, v65
  v_mul_f32 v230, s56, v66
  v_mul_f32 v231, s56, v67
  v_exp_f32_e64 v228, v228 clamp
  v_exp_f32_e64 v229, v229 clamp
  v_exp_f32_e64 v230, v230 clamp
  v_exp_f32_e64 v231, v231 clamp
  v_max_f32 v64, s36, v64
  v_max_f32 v65, s36, v65
  v_max_f32 v66, s36, v66
  v_max_f32 v67, s36, v67
  v_add_f32 v228, v228, v64
  v_add_f32 v229, v229, v65
  v_add_f32 v230, v230, v66
  v_add_f32 v231, v231, v67
  v_cvt_pk_bf16_f32 v204, v228, v229
  v_cvt_pk_bf16_f32 v205, v230, v231
  v_mul_f32 v228, s56, v68
  v_mul_f32 v229, s56, v69
  v_mul_f32 v230, s56, v70
  v_mul_f32 v231, s56, v71
  v_exp_f32_e64 v228, v228 clamp
  v_exp_f32_e64 v229, v229 clamp
  v_exp_f32_e64 v230, v230 clamp
  v_exp_f32_e64 v231, v231 clamp
  v_max_f32 v68, s36, v68
  v_max_f32 v69, s36, v69
  v_max_f32 v70, s36, v70
  v_max_f32 v71, s36, v71
  v_add_f32 v228, v228, v68
  v_add_f32 v229, v229, v69
  v_add_f32 v230, v230, v70
  v_add_f32 v231, v231, v71
  v_cvt_pk_bf16_f32 v206, v228, v229
  v_cvt_pk_bf16_f32 v207, v230, v231
  v_cvt_pk_bf16_f32 v72, v72, v73
  v_cvt_pk_bf16_f32 v73, v74, v75
  v_cvt_pk_bf16_f32 v74, v76, v77
  v_cvt_pk_bf16_f32 v75, v78, v79
  v_cvt_pk_bf16_f32 v76, v80, v81
  v_cvt_pk_bf16_f32 v77, v82, v83
  v_cvt_pk_bf16_f32 v78, v84, v85
  v_cvt_pk_bf16_f32 v79, v86, v87
  v_cvt_pk_bf16_f32 v80, v88, v89
  v_cvt_pk_bf16_f32 v81, v90, v91
  v_cvt_pk_bf16_f32 v82, v92, v93
  v_cvt_pk_bf16_f32 v83, v94, v95
  v_cvt_pk_bf16_f32 v84, v96, v97
  v_cvt_pk_bf16_f32 v85, v98, v99
  v_cvt_pk_bf16_f32 v86, v100, v101
  v_cvt_pk_bf16_f32 v87, v102, v103
  v_and_b32 v212, 16, v0
  v_cmp_ne_u32 vcc, 0, v212
  v_lshlrev_b32 v212, 6, v0
  v_mfma_f32_16x16x32_bf16 v[40:43], v[192:195], v[72:75], 0
  v_mfma_f32_16x16x32_bf16 v[44:47], v[200:203], v[72:75], 0
  v_mfma_f32_16x16x32_bf16 v[48:51], v[192:195], v[80:83], 0
  v_mfma_f32_16x16x32_bf16 v[52:55], v[200:203], v[80:83], 0
  v_mfma_f32_16x16x32_bf16 v[56:59], v[224:227], v[192:195], 0
  v_mfma_f32_16x16x32_bf16 v[60:63], v[224:227], v[200:203], 0
  v_mfma_f32_16x16x32_bf16 v[40:43], v[196:199], v[76:79], v[40:43]
  v_mfma_f32_16x16x32_bf16 v[44:47], v[204:207], v[76:79], v[44:47]
  v_mfma_f32_16x16x32_bf16 v[48:51], v[196:199], v[84:87], v[48:51]
  v_mfma_f32_16x16x32_bf16 v[52:55], v[204:207], v[84:87], v[52:55]
  v_mfma_f32_16x16x32_bf16 v[56:59], v[224:227], v[196:199], v[56:59]
  v_mfma_f32_16x16x32_bf16 v[60:63], v[224:227], v[204:207], v[60:63]
  s_nop 7
  s_cmp_eq_u32 s32, 0
  s_cbranch_scc1 L_wm0_22
  ds_write_b128 v3, v[40:43]
  ds_write_b128 v3, v[44:47] offset:1024
  s_nop 0
  v_mov_b32 v40, v48
  v_mov_b32 v41, v49
  v_mov_b32 v42, v50
  v_mov_b32 v43, v51
  v_mov_b32 v44, v52
  v_mov_b32 v45, v53
  v_mov_b32 v46, v54
  v_mov_b32 v47, v55
  s_branch L_wmj_23
L_wm0_22:
  ds_write_b128 v3, v[48:51]
  ds_write_b128 v3, v[52:55] offset:1024
L_wmj_23:
  v_cndmask_b32 v56, v56, v60, vcc
  ds_write_b32 v6, v56 offset:2048
  ds_write_b32 v208, v211 offset:16
  s_mov_b32 s58, 0
L_spin_24:
  ds_read_b32 v213, v209 offset:16
  s_waitcnt lgkmcnt(0)
  v_readfirstlane_b32 s59, v213
  s_add_u32 s58, s58, 1
  s_cmp_eq_u32 s59, 1
  s_cbranch_scc1 L_spun_25
  s_cmp_lt_u32 s58, 4194304
  s_cbranch_scc1 L_spin_24
L_spun_25:
  ds_read_b128 v[92:95], v4
  ds_read_b128 v[96:99], v4 offset:1024
  ds_read_b32 v213, v7 offset:2048
  s_lshl_b32 s3, s32, 4
  s_waitcnt lgkmcnt(0)
  v_add_f32 v40, v40, v92
  v_add_f32 v41, v41, v93
  v_add_f32 v42, v42, v94
  v_add_f32 v43, v43, v95
  v_add_f32 v44, v44, v96
  v_add_f32 v45, v45, v97
  v_add_f32 v46, v46, v98
  v_add_f32 v47, v47, v99
  v_cvt_pk_bf16_f32 v48, v40, v41
  v_cvt_pk_bf16_f32 v49, v42, v43
  v_cvt_pk_bf16_f32 v50, v44, v45
  v_cvt_pk_bf16_f32 v51, v46, v47
  v_add_f32 v56, v56, v213
  buffer_store_dwordx4 v[48:51], v2, s[12:15], s61 offen sc1
  s_lshl_b64 exec, 0xffff, s3
  buffer_store_dword v56, v212, s[12:15], s63 offen sc1
  s_mov_b64 exec, -1
  v_mfma_f32_16x16x32_bf16 v[8:11], v[120:123], v[104:107], v[8:11]
  v_mfma_f32_16x16x32_bf16 v[12:15], v[120:123], v[108:111], v[12:15]
  v_mfma_f32_16x16x32_bf16 v[16:19], v[120:123], v[112:115], v[16:19]
  v_mfma_f32_16x16x32_bf16 v[20:23], v[120:123], v[116:119], v[20:23]
  v_mfma_f32_16x16x32_bf16 v[36:39], v[124:127], v[116:119], v[36:39]
  v_mfma_f32_16x16x32_bf16 v[32:35], v[124:127], v[112:115], v[32:35]
  v_mfma_f32_16x16x32_bf16 v[28:31], v[124:127], v[108:111], v[28:31]
  v_mfma_f32_16x16x32_bf16 v[24:27], v[124:127], v[104:107], v[24:27]
  v_mfma_f32_16x16x32_bf16 v[8:11], v[160:163], v[144:147], v[8:11]
  v_mfma_f32_16x16x32_bf16 v[12:15], v[160:163], v[148:151], v[12:15]
  v_mfma_f32_16x16x32_bf16 v[16:19], v[160:163], v[152:155], v[16:19]
  v_mfma_f32_16x16x32_bf16 v[20:23], v[160:163], v[156:159], v[20:23]
  v_mfma_f32_16x16x32_bf16 v[36:39], v[164:167], v[156:159], v[36:39]
  v_mfma_f32_16x16x32_bf16 v[32:35], v[164:167], v[152:155], v[32:35]
  v_mfma_f32_16x16x32_bf16 v[28:31], v[164:167], v[148:151], v[28:31]
  v_mfma_f32_16x16x32_bf16 v[24:27], v[164:167], v[144:147], v[24:27]
  s_nop 0
  v_mul_f32 v228, s56, v8
  v_mul_f32 v229, s56, v9
  v_mul_f32 v230, s56, v10
  v_mul_f32 v231, s56, v11
  v_exp_f32_e64 v228, v228 clamp
  v_exp_f32_e64 v229, v229 clamp
  v_exp_f32_e64 v230, v230 clamp
  v_exp_f32_e64 v231, v231 clamp
  v_max_f32 v8, s36, v8
  v_max_f32 v9, s36, v9
  v_max_f32 v10, s36, v10
  v_max_f32 v11, s36, v11
  v_add_f32 v228, v228, v8
  v_add_f32 v229, v229, v9
  v_add_f32 v230, v230, v10
  v_add_f32 v231, v231, v11
  v_cvt_pk_bf16_f32 v192, v228, v229
  v_cvt_pk_bf16_f32 v193, v230, v231
  v_mul_f32 v228, s56, v12
  v_mul_f32 v229, s56, v13
  v_mul_f32 v230, s56, v14
  v_mul_f32 v231, s56, v15
  v_exp_f32_e64 v228, v228 clamp
  v_exp_f32_e64 v229, v229 clamp
  v_exp_f32_e64 v230, v230 clamp
  v_exp_f32_e64 v231, v231 clamp
  v_max_f32 v12, s36, v12
  v_max_f32 v13, s36, v13
  v_max_f32 v14, s36, v14
  v_max_f32 v15, s36, v15
  v_add_f32 v228, v228, v12
  v_add_f32 v229, v229, v13
  v_add_f32 v230, v230, v14
  v_add_f32 v231, v231, v15
  v_cvt_pk_bf16_f32 v196, v228, v229
  v_cvt_pk_bf16_f32 v197, v230, v231
  v_mul_f32 v228, s56, v16
  v_mul_f32 v229, s56, v17
  v_mul_f32 v230, s56, v18
  v_mul_f32 v231, s56, v19
  v_exp_f32_e64 v228, v228 clamp
  v_exp_f32_e64 v229, v229 clamp
  v_exp_f32_e64 v230, v230 clamp
  v_exp_f32_e64 v231, v231 clamp
  v_max_f32 v16, s36, v16
  v_max_f32 v17, s36, v17
  v_max_f32 v18, s36, v18
  v_max_f32 v19, s36, v19
  v_add_f32 v228, v228, v16
  v_add_f32 v229, v229, v17
  v_add_f32 v230, v230, v18
  v_add_f32 v231, v231, v19
  v_cvt_pk_bf16_f32 v200, v228, v229
  v_cvt_pk_bf16_f32 v201, v230, v231
  v_mul_f32 v228, s56, v20
  v_mul_f32 v229, s56, v21
  v_mul_f32 v230, s56, v22
  v_mul_f32 v231, s56, v23
  v_exp_f32_e64 v228, v228 clamp
  v_exp_f32_e64 v229, v229 clamp
  v_exp_f32_e64 v230, v230 clamp
  v_exp_f32_e64 v231, v231 clamp
  v_max_f32 v20, s36, v20
  v_max_f32 v21, s36, v21
  v_max_f32 v22, s36, v22
  v_max_f32 v23, s36, v23
  v_add_f32 v228, v228, v20
  v_add_f32 v229, v229, v21
  v_add_f32 v230, v230, v22
  v_add_f32 v231, v231, v23
  v_cvt_pk_bf16_f32 v204, v228, v229
  v_cvt_pk_bf16_f32 v205, v230, v231
  s_waitcnt vmcnt(0)
  ds_read_b64 v[214:215], v210 offset:0
  v_lshlrev_b32 v212, 7, v0
  s_mov_b64 exec, 1
  ds_add_rtn_u32 v213, v210, v211 offset:48
  s_lshl_b32 s94, s28, 11
  s_add_u32 s94, s94, 13697024
  s_lshl_b32 s95, s27, 3
  s_add_u32 s95, s95, s94
  s_mov_b64 exec, 0xffff
  s_waitcnt lgkmcnt(0)
  v_readfirstlane_b32 s3, v213
  s_nop 0
  s_cmp_lg_u32 s3, 3
  s_cbranch_scc1 L_nopub_26
  buffer_store_dwordx2 v[214:215], v212, s[12:15], s95 offen sc1
L_nopub_26:
  s_mov_b64 exec, -1
  s_lshl_b32 s3, s27, 7
  s_add_u32 s94, s94, s3
  s_lshl_b32 s98, s27, 7
  s_lshl_b32 s3, s28, 3
  s_add_u32 s98, s98, s3
  s_lshl_b32 s3, s24, 1
  s_add_u32 s98, s98, s3
  s_lshl_b32 s99, s98, 11
  v_lshlrev_b32 v213, 5, v0
  s_lshl_b32 s63, s98, 3
  s_add_u32 s63, s63, 12582912
  buffer_load_dwordx4 v[240:243], v213, s[4:7], s99 offen offset:0
  buffer_load_dwordx4 v[244:247], v213, s[4:7], s99 offen offset:16
  buffer_load_dwordx4 v[248:251], v213, s[4:7], s99 offen offset:2048
  buffer_load_dwordx4 v[252:255], v213, s[4:7], s99 offen offset:2064
  v_mul_f32 v228, s56, v24
  v_mul_f32 v229, s56, v25
  v_mul_f32 v230, s56, v26
  v_mul_f32 v231, s56, v27
  v_exp_f32_e64 v228, v228 clamp
  v_exp_f32_e64 v229, v229 clamp
  v_exp_f32_e64 v230, v230 clamp
  v_exp_f32_e64 v231, v231 clamp
  v_max_f32 v24, s36, v24
  v_max_f32 v25, s36, v25
  v_max_f32 v26, s36, v26
  v_max_f32 v27, s36, v27
  v_add_f32 v228, v228, v24
  v_add_f32 v229, v229, v25
  v_add_f32 v230, v230, v26
  v_add_f32 v231, v231, v27
  v_cvt_pk_bf16_f32 v194, v228, v229
  v_cvt_pk_bf16_f32 v195, v230, v231
  v_mul_f32 v228, s56, v28
  v_mul_f32 v229, s56, v29
  v_mul_f32 v230, s56, v30
  v_mul_f32 v231, s56, v31
  v_exp_f32_e64 v228, v228 clamp
  v_exp_f32_e64 v229, v229 clamp
  v_exp_f32_e64 v230, v230 clamp
  v_exp_f32_e64 v231, v231 clamp
  v_max_f32 v28, s36, v28
  v_max_f32 v29, s36, v29
  v_max_f32 v30, s36, v30
  v_max_f32 v31, s36, v31
  v_add_f32 v228, v228, v28
  v_add_f32 v229, v229, v29
  v_add_f32 v230, v230, v30
  v_add_f32 v231, v231, v31
  v_cvt_pk_bf16_f32 v198, v228, v229
  v_cvt_pk_bf16_f32 v199, v230, v231
  v_mul_f32 v228, s56, v32
  v_mul_f32 v229, s56, v33
  v_mul_f32 v230, s56, v34
  v_mul_f32 v231, s56, v35
  v_exp_f32_e64 v228, v228 clamp
  v_exp_f32_e64 v229, v229 clamp
  v_exp_f32_e64 v230, v230 clamp
  v_exp_f32_e64 v231, v231 clamp
  v_max_f32 v32, s36, v32
  v_max_f32 v33, s36, v33
  v_max_f32 v34, s36, v34
  v_max_f32 v35, s36, v35
  v_add_f32 v228, v228, v32
  v_add_f32 v229, v229, v33
  v_add_f32 v230, v230, v34
  v_add_f32 v231, v231, v35
  v_cvt_pk_bf16_f32 v202, v228, v229
  v_cvt_pk_bf16_f32 v203, v230, v231
  v_mul_f32 v228, s56, v36
  v_mul_f32 v229, s56, v37
  v_mul_f32 v230, s56, v38
  v_mul_f32 v231, s56, v39
  v_exp_f32_e64 v228, v228 clamp
  v_exp_f32_e64 v229, v229 clamp
  v_exp_f32_e64 v230, v230 clamp
  v_exp_f32_e64 v231, v231 clamp
  v_max_f32 v36, s36, v36
  v_max_f32 v37, s36, v37
  v_max_f32 v38, s36, v38
  v_max_f32 v39, s36, v39
  v_add_f32 v228, v228, v36
  v_add_f32 v229, v229, v37
  v_add_f32 v230, v230, v38
  v_add_f32 v231, v231, v39
  v_cvt_pk_bf16_f32 v206, v228, v229
  v_cvt_pk_bf16_f32 v207, v230, v231
  v_mov_b32 v128, 0
  v_mov_b32 v129, 0
  v_mov_b32 v132, 0
  v_mov_b32 v133, 0
  v_bfe_u32 v124, v0, 2, 2
  v_lshrrev_b32 v125, 4, v0
  v_cmp_eq_u32 vcc, v124, v125
  v_and_b32 v124, 1, v0
  v_lshlrev_b32 v124, 4, v124
  v_mov_b32 v125, 0x3f80
  v_lshlrev_b32 v124, v124, v125
  v_cndmask_b32 v124, 0, v124, vcc
  v_and_b32 v125, 2, v0
  v_cmp_eq_u32 vcc, 0, v125
  s_nop 1
  v_cndmask_b32 v130, 0, v124, vcc
  v_cndmask_b32 v131, v124, 0, vcc
  v_readfirstlane_b32 s96, v214
  v_readfirstlane_b32 s97, v215
  v_and_b32 v222, 31, v0
  v_lshlrev_b32 v222, 6, v222
  v_lshrrev_b32 v213, 5, v0
  v_lshl_add_u32 v222, v213, 5, v222
  s_cmp_lg_u32 s24, 0
  s_cbranch_scc1 L_pw_27
  v_and_b32 v212, 15, v0
  v_lshlrev_b32 v212, 3, v212
  s_mov_b32 s58, 0
  buffer_load_dwordx2 v[216:217], v212, s[12:15], s94 offen sc1
  s_sleep 6
L_gp_31:
  buffer_load_dwordx2 v[218:219], v212, s[12:15], s94 offen sc1
  s_waitcnt vmcnt(1)
  v_cmp_ne_u64 vcc, s[96:97], v[216:217]
  s_add_u32 s58, s58, 1
  s_nop 3
  s_cbranch_vccz L_po_30
  buffer_load_dwordx2 v[216:217], v212, s[12:15], s94 offen sc1
  s_waitcnt vmcnt(1)
  v_cmp_ne_u64 vcc, s[96:97], v[218:219]
  s_add_u32 s58, s58, 1
  s_nop 3
  s_cbranch_vccz L_po_30
  s_cmp_lt_u32 s58, 4194304
  s_cbranch_scc1 L_gp_31
L_po_30:
  ds_write_b32 v210, v211 offset:52
  s_branch L_pd_28
L_pw_27:
  s_mov_b32 s58, 0
L_spin_32:
  ds_read_b32 v213, v210 offset:52
  s_waitcnt lgkmcnt(0)
  v_readfirstlane_b32 s59, v213
  s_add_u32 s58, s58, 1
  s_cmp_eq_u32 s59, 1
  s_cbranch_scc1 L_spun_33
  s_sleep 1
  s_cmp_lt_u32 s58, 4194304
  s_cbranch_scc1 L_spin_32
L_spun_33:
L_pd_28:
  buffer_load_dwordx4 v[168:171], v222, s[12:15], s62 offen sc1
  buffer_load_dwordx4 v[172:175], v222, s[12:15], s62 offen offset:16 sc1
  s_add_u32 s3, s60, 0
  buffer_load_dwordx4 v[8:11], v2, s[12:15], s3 offen offset:0 sc1
  buffer_load_dwordx4 v[12:15], v2, s[12:15], s3 offen offset:1024 sc1
  buffer_load_dwordx4 v[16:19], v2, s[12:15], s3 offen offset:2048 sc1
  buffer_load_dwordx4 v[20:23], v2, s[12:15], s3 offen offset:3072 sc1
  s_add_u32 s3, s60, 4096
  buffer_load_dwordx4 v[24:27], v2, s[12:15], s3 offen offset:0 sc1
  buffer_load_dwordx4 v[28:31], v2, s[12:15], s3 offen offset:1024 sc1
  buffer_load_dwordx4 v[32:35], v2, s[12:15], s3 offen offset:2048 sc1
  buffer_load_dwordx4 v[36:39], v2, s[12:15], s3 offen offset:3072 sc1
  s_add_u32 s3, s60, 8192
  buffer_load_dwordx4 v[40:43], v2, s[12:15], s3 offen offset:0 sc1
  buffer_load_dwordx4 v[44:47], v2, s[12:15], s3 offen offset:1024 sc1
  buffer_load_dwordx4 v[48:51], v2, s[12:15], s3 offen offset:2048 sc1
  buffer_load_dwordx4 v[52:55], v2, s[12:15], s3 offen offset:3072 sc1
  s_add_u32 s3, s60, 12288
  buffer_load_dwordx4 v[56:59], v2, s[12:15], s3 offen offset:0 sc1
  buffer_load_dwordx4 v[60:63], v2, s[12:15], s3 offen offset:1024 sc1
  buffer_load_dwordx4 v[64:67], v2, s[12:15], s3 offen offset:2048 sc1
  buffer_load_dwordx4 v[68:71], v2, s[12:15], s3 offen offset:3072 sc1
  s_waitcnt vmcnt(16)
  v_add_f32 v168, v168, v172
  v_add_f32 v169, v169, v173
  v_add_f32 v170, v170, v174
  v_add_f32 v171, v171, v175
  v_add_f32 v168, v168, v169
  v_add_f32 v170, v170, v171
  v_add_f32 v168, v168, v170
  v_mov_b32 v169, v168
  s_lshl_b32 s3, s24, 8
  s_add_u32 s3, s3, 161920
  v_add_u32 v212, s3, v5
  v_and_b32 v213, 48, v0
  v_add_u32 v213, s3, v213
  v_permlane32_swap_b32 v168, v169
  v_add_f32 v168, v168, v169
  ds_write_b32 v212, v168
  ds_read_b128 v[216:219], v213
  ds_read_b128 v[220:223], v213 offset:64
  s_lshl_b32 s3, s27, 3
  s_lshl_b32 s61, s32, 2
  s_add_u32 s3, s3, s61
  s_lshl_b32 s3, s3, 15
  s_lshl_b32 s61, s34, 10
  s_add_u32 s61, s61, s3
  s_mul_i32 s3, s33, 6144
  s_add_u32 s3, s3, 110592
  v_add_u32 v212, s3, v2
  s_waitcnt lgkmcnt(0)
  v_cvt_pk_bf16_f32 v144, v216, v217
  v_cvt_pk_bf16_f32 v145, v218, v219
  v_cvt_pk_bf16_f32 v146, v220, v221
  v_cvt_pk_bf16_f32 v147, v222, v223
  s_nop 1
  v_mfma_f32_16x16x32_bf16 v[152:155], v[144:147], v[192:195], 0
  v_mfma_f32_16x16x32_bf16 v[156:159], v[144:147], v[196:199], 0
  v_mfma_f32_16x16x32_bf16 v[160:163], v[144:147], v[200:203], 0
  v_mfma_f32_16x16x32_bf16 v[164:167], v[144:147], v[204:207], 0
  s_waitcnt vmcnt(15)
  v_mfma_f32_16x16x32_bf16 v[80:83], v[130:133], v[8:11], 0
  v_mfma_f32_16x16x32_bf16 v[84:87], v[128:131], v[8:11], 0
  s_waitcnt vmcnt(14)
  v_mfma_f32_16x16x32_bf16 v[80:83], v[130:133], v[12:15], v[80:83]
  v_mfma_f32_16x16x32_bf16 v[84:87], v[128:131], v[12:15], v[84:87]
  s_waitcnt vmcnt(13)
  v_mfma_f32_16x16x32_bf16 v[80:83], v[130:133], v[16:19], v[80:83]
  v_mfma_f32_16x16x32_bf16 v[84:87], v[128:131], v[16:19], v[84:87]
  s_waitcnt vmcnt(12)
  v_mfma_f32_16x16x32_bf16 v[80:83], v[130:133], v[20:23], v[80:83]
  v_mfma_f32_16x16x32_bf16 v[84:87], v[128:131], v[20:23], v[84:87]
  s_waitcnt vmcnt(11)
  v_mfma_f32_16x16x32_bf16 v[80:83], v[130:133], v[24:27], v[80:83]
  v_mfma_f32_16x16x32_bf16 v[84:87], v[128:131], v[24:27], v[84:87]
  v_add_f32 v152, s36, v152
  v_rcp_f32 v152, v152
  v_add_f32 v156, s36, v156
  v_rcp_f32 v156, v156
  v_add_f32 v160, s36, v160
  v_rcp_f32 v160, v160
  v_add_f32 v164, s36, v164
  v_rcp_f32 v164, v164
  s_waitcnt vmcnt(10)
  v_mfma_f32_16x16x32_bf16 v[80:83], v[130:133], v[28:31], v[80:83]
  v_mfma_f32_16x16x32_bf16 v[84:87], v[128:131], v[28:31], v[84:87]
  s_waitcnt vmcnt(9)
  v_mfma_f32_16x16x32_bf16 v[80:83], v[130:133], v[32:35], v[80:83]
  v_mfma_f32_16x16x32_bf16 v[84:87], v[128:131], v[32:35], v[84:87]
  s_waitcnt vmcnt(8)
  v_mfma_f32_16x16x32_bf16 v[80:83], v[130:133], v[36:39], v[80:83]
  v_mfma_f32_16x16x32_bf16 v[84:87], v[128:131], v[36:39], v[84:87]
  s_waitcnt vmcnt(7)
  v_mfma_f32_16x16x32_bf16 v[80:83], v[130:133], v[40:43], v[80:83]
  v_mfma_f32_16x16x32_bf16 v[84:87], v[128:131], v[40:43], v[84:87]
  s_waitcnt vmcnt(6)
  v_mfma_f32_16x16x32_bf16 v[80:83], v[130:133], v[44:47], v[80:83]
  v_mfma_f32_16x16x32_bf16 v[84:87], v[128:131], v[44:47], v[84:87]
  s_waitcnt vmcnt(5)
  v_mfma_f32_16x16x32_bf16 v[80:83], v[130:133], v[48:51], v[80:83]
  v_mfma_f32_16x16x32_bf16 v[84:87], v[128:131], v[48:51], v[84:87]
  s_waitcnt vmcnt(4)
  v_mfma_f32_16x16x32_bf16 v[80:83], v[130:133], v[52:55], v[80:83]
  v_mfma_f32_16x16x32_bf16 v[84:87], v[128:131], v[52:55], v[84:87]
  s_waitcnt vmcnt(3)
  v_mfma_f32_16x16x32_bf16 v[80:83], v[130:133], v[56:59], v[80:83]
  v_mfma_f32_16x16x32_bf16 v[84:87], v[128:131], v[56:59], v[84:87]
  s_waitcnt vmcnt(2)
  v_mfma_f32_16x16x32_bf16 v[80:83], v[130:133], v[60:63], v[80:83]
  v_mfma_f32_16x16x32_bf16 v[84:87], v[128:131], v[60:63], v[84:87]
  s_waitcnt vmcnt(1)
  v_mfma_f32_16x16x32_bf16 v[80:83], v[130:133], v[64:67], v[80:83]
  v_mfma_f32_16x16x32_bf16 v[84:87], v[128:131], v[64:67], v[84:87]
  s_waitcnt vmcnt(0)
  v_mfma_f32_16x16x32_bf16 v[80:83], v[130:133], v[68:71], v[80:83]
  v_mfma_f32_16x16x32_bf16 v[84:87], v[128:131], v[68:71], v[84:87]
  s_nop 6
  v_cvt_pk_bf16_f32 v148, v80, v81
  v_cvt_pk_bf16_f32 v149, v82, v83
  v_cvt_pk_bf16_f32 v150, v84, v85
  v_cvt_pk_bf16_f32 v151, v86, v87
  ds_write_b128 v3, v[148:151]
  ds_write_b32 v208, v211 offset:32
  s_mov_b32 s58, 0
L_spin_34:
  ds_read_b32 v213, v209 offset:32
  s_waitcnt lgkmcnt(0)
  v_readfirstlane_b32 s59, v213
  s_add_u32 s58, s58, 1
  s_cmp_eq_u32 s59, 1
  s_cbranch_scc1 L_spun_35
  s_cmp_lt_u32 s58, 4194304
  s_cbranch_scc1 L_spin_34
L_spun_35:
  ds_read_b128 v[136:139], v212
  ds_read_b128 v[140:143], v212 offset:3072
  s_waitcnt lgkmcnt(0)
  v_mfma_f32_16x16x32_bf16 v[88:91], v[136:139], v[192:195], 0
  v_mfma_f32_16x16x32_bf16 v[92:95], v[140:143], v[192:195], 0
  v_mfma_f32_16x16x32_bf16 v[96:99], v[136:139], v[196:199], 0
  v_mfma_f32_16x16x32_bf16 v[100:103], v[140:143], v[196:199], 0
  v_mfma_f32_16x16x32_bf16 v[104:107], v[136:139], v[200:203], 0
  v_mfma_f32_16x16x32_bf16 v[108:111], v[140:143], v[200:203], 0
  v_mfma_f32_16x16x32_bf16 v[112:115], v[136:139], v[204:207], 0
  v_mfma_f32_16x16x32_bf16 v[116:119], v[140:143], v[204:207], 0
  s_nop 0
  v_mul_f32 v88, v88, v152
  v_mul_f32 v89, v89, v152
  v_mul_f32 v90, v90, v152
  v_mul_f32 v91, v91, v152
  v_mul_f32 v92, v92, v152
  v_mul_f32 v93, v93, v152
  v_mul_f32 v94, v94, v152
  v_mul_f32 v95, v95, v152
  v_cvt_pk_bf16_f32 v64, v88, v89
  v_cvt_pk_bf16_f32 v65, v90, v91
  v_cvt_pk_bf16_f32 v66, v92, v93
  v_cvt_pk_bf16_f32 v67, v94, v95
  s_add_u32 s3, s61, 0
  buffer_store_dwordx4 v[64:67], v2, s[12:15], s3 offen sc1
  v_mul_f32 v96, v96, v156
  v_mul_f32 v97, v97, v156
  v_mul_f32 v98, v98, v156
  v_mul_f32 v99, v99, v156
  v_mul_f32 v100, v100, v156
  v_mul_f32 v101, v101, v156
  v_mul_f32 v102, v102, v156
  v_mul_f32 v103, v103, v156
  v_cvt_pk_bf16_f32 v68, v96, v97
  v_cvt_pk_bf16_f32 v69, v98, v99
  v_cvt_pk_bf16_f32 v70, v100, v101
  v_cvt_pk_bf16_f32 v71, v102, v103
  s_add_u32 s3, s61, 32768
  buffer_store_dwordx4 v[68:71], v2, s[12:15], s3 offen sc1
  v_mul_f32 v104, v104, v160
  v_mul_f32 v105, v105, v160
  v_mul_f32 v106, v106, v160
  v_mul_f32 v107, v107, v160
  v_mul_f32 v108, v108, v160
  v_mul_f32 v109, v109, v160
  v_mul_f32 v110, v110, v160
  v_mul_f32 v111, v111, v160
  v_cvt_pk_bf16_f32 v72, v104, v105
  v_cvt_pk_bf16_f32 v73, v106, v107
  v_cvt_pk_bf16_f32 v74, v108, v109
  v_cvt_pk_bf16_f32 v75, v110, v111
  s_add_u32 s3, s61, 65536
  buffer_store_dwordx4 v[72:75], v2, s[12:15], s3 offen sc1
  v_mul_f32 v112, v112, v164
  v_mul_f32 v113, v113, v164
  v_mul_f32 v114, v114, v164
  v_mul_f32 v115, v115, v164
  v_mul_f32 v116, v116, v164
  v_mul_f32 v117, v117, v164
  v_mul_f32 v118, v118, v164
  v_mul_f32 v119, v119, v164
  v_cvt_pk_bf16_f32 v76, v112, v113
  v_cvt_pk_bf16_f32 v77, v114, v115
  v_cvt_pk_bf16_f32 v78, v116, v117
  v_cvt_pk_bf16_f32 v79, v118, v119
  s_add_u32 s3, s61, 98304
  buffer_store_dwordx4 v[76:79], v2, s[12:15], s3 offen sc1
  s_and_b32 s38, s24, 3
  s_lshr_b32 s39, s24, 2
  s_and_b32 s36, s30, 1
  s_xor_b32 s36, s36, s39
  v_lshlrev_b32 v2, 4, v0
  v_bfe_u32 v4, v0, 2, 2
  v_lshrrev_b32 v3, 4, v0
  v_lshl_add_u32 v4, v3, 2, v4
  v_and_b32 v6, 3, v0
  v_lshlrev_b32 v6, 3, v6
  v_lshl_add_u32 v6, v4, 7, v6
  s_cmp_eq_u32 s39, 0
  s_cselect_b32 s3, 40960, 0
  s_lshl_b32 s99, s39, 16
  s_add_u32 s99, s99, 40960
  v_add_u32 v6, s3, v6
  v_bfe_u32 v7, v4, 1, 2
  v_xor_b32 v3, 0, v7
  v_lshl_add_u32 v184, v3, 5, v6
  v_add_u32 v188, s99, v184
  v_xor_b32 v3, 1, v7
  v_lshl_add_u32 v185, v3, 5, v6
  v_add_u32 v189, s99, v185
  v_xor_b32 v3, 2, v7
  v_lshl_add_u32 v186, v3, 5, v6
  v_add_u32 v190, s99, v186
  v_xor_b32 v3, 3, v7
  v_lshl_add_u32 v187, v3, 5, v6
  v_add_u32 v191, s99, v187
  s_lshl_b32 s3, s24, 12
  s_add_u32 s3, s3, 131072
  v_add_u32 v178, s3, v2
  s_xor_b32 s3, s3, 16384
  v_add_u32 v179, s3, v2
  s_lshl_b32 s3, s39, 2
  s_add_u32 s3, s3, 161792
  v_mov_b32 v180, s3
  s_lshl_b32 s3, s30, 11
  s_lshl_b32 s99, s31, 7
  s_add_u32 s3, s3, s99
  s_lshl_b32 s99, s36, 6
  s_add_u32 s3, s3, s99
  s_add_u32 s3, s3, 13762560
  v_and_b32 v181, 7, v0
  v_lshl_add_u32 v181, v181, 3, s3
  s_lshl_b32 s3, s31, 8
  s_add_u32 s3, s3, 13639680
  s_lshl_b32 s99, s30, 8
  s_add_u32 s99, s99, 13647872
  v_and_b32 v183, 16, v0
  v_cmp_ne_u32 vcc, 0, v183
  v_mov_b32 v182, s3
  v_mov_b32 v183, s99
  v_cndmask_b32 v183, v182, v183, vcc
  v_and_b32 v182, 15, v0
  v_lshl_add_u32 v182, v182, 3, v183
  v_mov_b32 v183, 1
  s_lshl_b32 s98, s30, 3
  s_lshl_b32 s3, s38, 1
  s_add_u32 s98, s98, s3
  s_add_u32 s98, s98, s39
  s_lshl_b32 s32, s98, 15
  s_lshl_b32 s3, s36, 14
  s_add_u32 s32, s32, s3
  s_xor_b32 s33, s32, 32768
  v_and_b32 v3, 15, v0
  v_lshrrev_b32 v4, 4, v0
  v_lshlrev_b32 v6, 3, v3
  v_lshl_add_u32 v5, v4, 14, v6
  s_lshl_b32 s3, s98, 7
  s_add_u32 s35, s3, 12582912
  s_lshl_b32 s34, s31, 18
  s_add_u32 s34, s34, s3
  s_add_u32 s34, s34, 8388608
  v_lshlrev_b32 v7, 11, v3
  v_and_b32 v3, 1, v4
  v_lshl_add_u32 v7, v3, 5, v7
  v_lshrrev_b32 v3, 1, v4
  v_lshl_add_u32 v7, v3, 4, v7
  s_lshl_b32 s37, s98, 15
  s_lshl_b32 s3, s31, 7
  s_add_u32 s37, s37, s3
  s_waitcnt vmcnt(0)
  ds_read_b64 v[214:215], v210 offset:0
  v_lshlrev_b32 v212, 7, v0
  s_mov_b64 exec, 1
  ds_add_rtn_u32 v213, v210, v211 offset:56
  s_lshl_b32 s94, s27, 11
  s_add_u32 s94, s94, 13762560
  s_lshl_b32 s95, s28, 3
  s_add_u32 s95, s95, s94
  s_mov_b64 exec, 0xffff
  s_waitcnt lgkmcnt(0)
  v_readfirstlane_b32 s3, v213
  s_nop 0
  s_cmp_lg_u32 s3, 3
  s_cbranch_scc1 L_nopub_36
  buffer_store_dwordx2 v[214:215], v212, s[12:15], s95 offen sc1
L_nopub_36:
  s_mov_b64 exec, -1
  v_lshlrev_b32 v104, 16, v232
  v_and_b32 v105, 0xffff0000, v232
  v_lshlrev_b32 v106, 16, v233
  v_and_b32 v107, 0xffff0000, v233
  v_lshlrev_b32 v108, 16, v234
  v_and_b32 v109, 0xffff0000, v234
  v_lshlrev_b32 v110, 16, v235
  v_and_b32 v111, 0xffff0000, v235
  v_lshlrev_b32 v112, 16, v236
  v_and_b32 v113, 0xffff0000, v236
  v_lshlrev_b32 v114, 16, v237
  v_and_b32 v115, 0xffff0000, v237
  v_lshlrev_b32 v116, 16, v238
  v_and_b32 v117, 0xffff0000, v238
  v_lshlrev_b32 v118, 16, v239
  v_and_b32 v119, 0xffff0000, v239
  v_mov_b32 v120, 0
  v_mov_b32 v121, 0
  v_lshlrev_b32 v124, 16, v240
  v_and_b32 v125, 0xffff0000, v240
  v_lshlrev_b32 v126, 16, v248
  v_and_b32 v127, 0xffff0000, v248
  v_mul_f32 v124, v124, v104
  v_mul_f32 v125, v125, v105
  v_mul_f32 v126, v126, v104
  v_mul_f32 v127, v127, v105
  v_cvt_pk_bf16_f32 v124, v124, v125
  v_cvt_pk_bf16_f32 v126, v126, v127
  v_lshlrev_b32 v125, 16, v124
  v_and_b32 v124, 0xffff0000, v124
  v_lshlrev_b32 v127, 16, v126
  v_and_b32 v126, 0xffff0000, v126
  v_add_f32 v124, v124, v125
  v_add_f32 v126, v126, v127
  v_add_f32 v120, v120, v124
  v_add_f32 v121, v121, v126
  v_lshlrev_b32 v124, 16, v241
  v_and_b32 v125, 0xffff0000, v241
  v_lshlrev_b32 v126, 16, v249
  v_and_b32 v127, 0xffff0000, v249
  v_mul_f32 v124, v124, v106
  v_mul_f32 v125, v125, v107
  v_mul_f32 v126, v126, v106
  v_mul_f32 v127, v127, v107
  v_cvt_pk_bf16_f32 v124, v124, v125
  v_cvt_pk_bf16_f32 v126, v126, v127
  v_lshlrev_b32 v125, 16, v124
  v_and_b32 v124, 0xffff0000, v124
  v_lshlrev_b32 v127, 16, v126
  v_and_b32 v126, 0xffff0000, v126
  v_add_f32 v124, v124, v125
  v_add_f32 v126, v126, v127
  v_add_f32 v120, v120, v124
  v_add_f32 v121, v121, v126
  v_lshlrev_b32 v124, 16, v242
  v_and_b32 v125, 0xffff0000, v242
  v_lshlrev_b32 v126, 16, v250
  v_and_b32 v127, 0xffff0000, v250
  v_mul_f32 v124, v124, v108
  v_mul_f32 v125, v125, v109
  v_mul_f32 v126, v126, v108
  v_mul_f32 v127, v127, v109
  v_cvt_pk_bf16_f32 v124, v124, v125
  v_cvt_pk_bf16_f32 v126, v126, v127
  v_lshlrev_b32 v125, 16, v124
  v_and_b32 v124, 0xffff0000, v124
  v_lshlrev_b32 v127, 16, v126
  v_and_b32 v126, 0xffff0000, v126
  v_add_f32 v124, v124, v125
  v_add_f32 v126, v126, v127
  v_add_f32 v120, v120, v124
  v_add_f32 v121, v121, v126
  v_lshlrev_b32 v124, 16, v243
  v_and_b32 v125, 0xffff0000, v243
  v_lshlrev_b32 v126, 16, v251
  v_and_b32 v127, 0xffff0000, v251
  v_mul_f32 v124, v124, v110
  v_mul_f32 v125, v125, v111
  v_mul_f32 v126, v126, v110
  v_mul_f32 v127, v127, v111
  v_cvt_pk_bf16_f32 v124, v124, v125
  v_cvt_pk_bf16_f32 v126, v126, v127
  v_lshlrev_b32 v125, 16, v124
  v_and_b32 v124, 0xffff0000, v124
  v_lshlrev_b32 v127, 16, v126
  v_and_b32 v126, 0xffff0000, v126
  v_add_f32 v124, v124, v125
  v_add_f32 v126, v126, v127
  v_add_f32 v120, v120, v124
  v_add_f32 v121, v121, v126
  v_lshlrev_b32 v124, 16, v244
  v_and_b32 v125, 0xffff0000, v244
  v_lshlrev_b32 v126, 16, v252
  v_and_b32 v127, 0xffff0000, v252
  v_mul_f32 v124, v124, v112
  v_mul_f32 v125, v125, v113
  v_mul_f32 v126, v126, v112
  v_mul_f32 v127, v127, v113
  v_cvt_pk_bf16_f32 v124, v124, v125
  v_cvt_pk_bf16_f32 v126, v126, v127
  v_lshlrev_b32 v125, 16, v124
  v_and_b32 v124, 0xffff0000, v124
  v_lshlrev_b32 v127, 16, v126
  v_and_b32 v126, 0xffff0000, v126
  v_add_f32 v124, v124, v125
  v_add_f32 v126, v126, v127
  v_add_f32 v120, v120, v124
  v_add_f32 v121, v121, v126
  v_lshlrev_b32 v124, 16, v245
  v_and_b32 v125, 0xffff0000, v245
  v_lshlrev_b32 v126, 16, v253
  v_and_b32 v127, 0xffff0000, v253
  v_mul_f32 v124, v124, v114
  v_mul_f32 v125, v125, v115
  v_mul_f32 v126, v126, v114
  v_mul_f32 v127, v127, v115
  v_cvt_pk_bf16_f32 v124, v124, v125
  v_cvt_pk_bf16_f32 v126, v126, v127
  v_lshlrev_b32 v125, 16, v124
  v_and_b32 v124, 0xffff0000, v124
  v_lshlrev_b32 v127, 16, v126
  v_and_b32 v126, 0xffff0000, v126
  v_add_f32 v124, v124, v125
  v_add_f32 v126, v126, v127
  v_add_f32 v120, v120, v124
  v_add_f32 v121, v121, v126
  v_lshlrev_b32 v124, 16, v246
  v_and_b32 v125, 0xffff0000, v246
  v_lshlrev_b32 v126, 16, v254
  v_and_b32 v127, 0xffff0000, v254
  v_mul_f32 v124, v124, v116
  v_mul_f32 v125, v125, v117
  v_mul_f32 v126, v126, v116
  v_mul_f32 v127, v127, v117
  v_cvt_pk_bf16_f32 v124, v124, v125
  v_cvt_pk_bf16_f32 v126, v126, v127
  v_lshlrev_b32 v125, 16, v124
  v_and_b32 v124, 0xffff0000, v124
  v_lshlrev_b32 v127, 16, v126
  v_and_b32 v126, 0xffff0000, v126
  v_add_f32 v124, v124, v125
  v_add_f32 v126, v126, v127
  v_add_f32 v120, v120, v124
  v_add_f32 v121, v121, v126
  v_lshlrev_b32 v124, 16, v247
  v_and_b32 v125, 0xffff0000, v247
  v_lshlrev_b32 v126, 16, v255
  v_and_b32 v127, 0xffff0000, v255
  v_mul_f32 v124, v124, v118
  v_mul_f32 v125, v125, v119
  v_mul_f32 v126, v126, v118
  v_mul_f32 v127, v127, v119
  v_cvt_pk_bf16_f32 v124, v124, v125
  v_cvt_pk_bf16_f32 v126, v126, v127
  v_lshlrev_b32 v125, 16, v124
  v_and_b32 v124, 0xffff0000, v124
  v_lshlrev_b32 v127, 16, v126
  v_and_b32 v126, 0xffff0000, v126
  v_add_f32 v124, v124, v125
  v_add_f32 v126, v126, v127
  v_add_f32 v120, v120, v124
  v_add_f32 v121, v121, v126
  s_nop 0
  v_add_f32_dpp v120, v120, v120 quad_perm:[1,0,3,2] row_mask:0xf bank_mask:0xf
  v_add_f32_dpp v121, v121, v121 quad_perm:[1,0,3,2] row_mask:0xf bank_mask:0xf
  s_nop 0
  v_add_f32_dpp v120, v120, v120 quad_perm:[2,3,0,1] row_mask:0xf bank_mask:0xf
  v_add_f32_dpp v121, v121, v121 quad_perm:[2,3,0,1] row_mask:0xf bank_mask:0xf
  s_nop 0
  v_add_f32_dpp v120, v120, v120 row_half_mirror row_mask:0xf bank_mask:0xf
  v_add_f32_dpp v121, v121, v121 row_half_mirror row_mask:0xf bank_mask:0xf
  s_nop 0
  v_add_f32_dpp v120, v120, v120 row_mirror row_mask:0xf bank_mask:0xf
  v_add_f32_dpp v121, v121, v121 row_mirror row_mask:0xf bank_mask:0xf
  s_nop 1
  v_permlane16_swap_b32 v120, v121
  v_add_f32 v120, v120, v121
  v_mov_b32 v121, v120
  s_nop 1
  v_permlane32_swap_b32 v120, v121
  v_add_f32 v120, v120, v121
  v_cvt_pk_bf16_f32 v120, v120, v120
  v_lshlrev_b32 v120, 16, v120
  v_mul_f32_e64 v120, -v120, s56
  v_exp_f32 v120, v120
  s_nop 0
  v_add_f32 v120, 1.0, v120
  v_rcp_f32 v120, v120
  s_nop 0
  v_cvt_pk_bf16_f32 v120, v120, v120
  v_lshlrev_b32 v120, 16, v120
  v_sub_f32 v121, 1.0, v120
  v_cvt_pk_bf16_f32 v121, v121, v121
  v_lshlrev_b32 v121, 16, v121
  v_lshrrev_b32 v124, 1, v0
  s_mov_b64 exec, 0x10001
  buffer_store_dwordx2 v[120:121], v124, s[12:15], s63 offen sc1
  s_mov_b64 exec, -1
  s_waitcnt vmcnt(0)
  s_mov_b64 exec, 1
  ds_add_rtn_u32 v213, v210, v211 offset:88
  ds_read_b64 v[214:215], v210 offset:0
  s_lshl_b32 s94, s27, 8
  s_add_u32 s94, s94, 13647872
  s_lshl_b32 s95, s28, 3
  s_add_u32 s95, s95, s94
  v_mov_b32 v212, 0
  s_waitcnt lgkmcnt(0)
  v_readfirstlane_b32 s3, v213
  s_nop 0
  s_cmp_lg_u32 s3, 3
  s_cbranch_scc1 L_nopub_37
  buffer_store_dwordx2 v[214:215], v212, s[12:15], s95 offen sc1
L_nopub_37:
  s_mov_b64 exec, -1
  s_setprio 0
L_phaseD:
  s_and_b32 s3, s24, 3
  s_cmp_lg_u32 s3, 0
  s_cbranch_scc1 L_ow_38
  s_mov_b32 s58, 0
  s_mov_b32 s58, 0
  buffer_load_dwordx2 v[240:241], v181, s[12:15], 0 offen sc1
  s_sleep 6
L_gp_42:
  buffer_load_dwordx2 v[242:243], v181, s[12:15], 0 offen sc1
  s_waitcnt vmcnt(1)
  v_cmp_ne_u64 vcc, s[96:97], v[240:241]
  s_add_u32 s58, s58, 1
  s_nop 3
  s_cbranch_vccz L_oo_41
  buffer_load_dwordx2 v[240:241], v181, s[12:15], 0 offen sc1
  s_waitcnt vmcnt(1)
  v_cmp_ne_u64 vcc, s[96:97], v[242:243]
  s_add_u32 s58, s58, 1
  s_nop 3
  s_cbranch_vccz L_oo_41
  s_cmp_lt_u32 s58, 4194304
  s_cbranch_scc1 L_gp_42
L_oo_41:
  ds_write_b32 v180, v183 offset:72
  s_branch L_od_39
L_ow_38:
  s_mov_b32 s58, 0
L_spin_43:
  ds_read_b32 v8, v180 offset:72
  s_waitcnt lgkmcnt(0)
  v_readfirstlane_b32 s59, v8
  s_add_u32 s58, s58, 1
  s_cmp_eq_u32 s59, 1
  s_cbranch_scc1 L_spun_44
  s_sleep 1
  s_cmp_lt_u32 s58, 4194304
  s_cbranch_scc1 L_spin_43
L_spun_44:
L_od_39:
  s_add_u32 s38, s32, 0
  s_add_u32 s39, s33, 0
  buffer_load_dwordx4 v[40:43], v2, s[12:15], s38 offen offset:0 sc1
  buffer_load_dwordx4 v[44:47], v2, s[12:15], s39 offen offset:0 sc1
  buffer_load_dwordx4 v[48:51], v2, s[12:15], s38 offen offset:1024 sc1
  buffer_load_dwordx4 v[52:55], v2, s[12:15], s39 offen offset:1024 sc1
  buffer_load_dwordx4 v[56:59], v2, s[12:15], s38 offen offset:2048 sc1
  buffer_load_dwordx4 v[60:63], v2, s[12:15], s39 offen offset:2048 sc1
  buffer_load_dwordx4 v[64:67], v2, s[12:15], s38 offen offset:3072 sc1
  buffer_load_dwordx4 v[68:71], v2, s[12:15], s39 offen offset:3072 sc1
  s_mov_b32 s58, 0
L_spin_45:
  ds_read_b32 v8, v180 offset:80
  s_waitcnt lgkmcnt(0)
  v_readfirstlane_b32 s59, v8
  s_add_u32 s58, s58, 1
  s_cmp_eq_u32 s59, 4
  s_cbranch_scc1 L_spun_46
  s_sleep 1
  s_cmp_lt_u32 s58, 4194304
  s_cbranch_scc1 L_spin_45
L_spun_46:
  ds_read_b64_tr_b16 v[192:193], v184 offset:0
  ds_read_b64_tr_b16 v[194:195], v184 offset:2048
  ds_read_b64_tr_b16 v[196:197], v185 offset:0
  ds_read_b64_tr_b16 v[198:199], v185 offset:2048
  ds_read_b64_tr_b16 v[200:201], v186 offset:0
  ds_read_b64_tr_b16 v[202:203], v186 offset:2048
  ds_read_b64_tr_b16 v[204:205], v187 offset:0
  ds_read_b64_tr_b16 v[206:207], v187 offset:2048
  ds_read_b64_tr_b16 v[208:209], v184 offset:4096
  ds_read_b64_tr_b16 v[210:211], v184 offset:6144
  ds_read_b64_tr_b16 v[212:213], v185 offset:4096
  ds_read_b64_tr_b16 v[214:215], v185 offset:6144
  ds_read_b64_tr_b16 v[216:217], v186 offset:4096
  ds_read_b64_tr_b16 v[218:219], v186 offset:6144
  ds_read_b64_tr_b16 v[220:221], v187 offset:4096
  ds_read_b64_tr_b16 v[222:223], v187 offset:6144
  s_add_u32 s38, s32, 4096
  s_add_u32 s39, s33, 4096
  buffer_load_dwordx4 v[72:75], v2, s[12:15], s38 offen offset:0 sc1
  buffer_load_dwordx4 v[76:79], v2, s[12:15], s39 offen offset:0 sc1
  s_waitcnt lgkmcnt(8)
  s_waitcnt vmcnt(8)
  v_mfma_f32_16x16x32_bf16 v[24:27], v[192:195], v[44:47], 0
  ds_read_b64_tr_b16 v[224:225], v184 offset:8192
  v_mfma_f32_16x16x32_bf16 v[28:31], v[196:199], v[44:47], 0
  ds_read_b64_tr_b16 v[226:227], v184 offset:10240
  v_mfma_f32_16x16x32_bf16 v[32:35], v[200:203], v[44:47], 0
  ds_read_b64_tr_b16 v[228:229], v185 offset:8192
  v_mfma_f32_16x16x32_bf16 v[36:39], v[204:207], v[44:47], 0
  ds_read_b64_tr_b16 v[230:231], v185 offset:10240
  v_mfma_f32_16x16x32_bf16 v[20:23], v[204:207], v[40:43], 0
  ds_read_b64_tr_b16 v[232:233], v186 offset:8192
  v_mfma_f32_16x16x32_bf16 v[16:19], v[200:203], v[40:43], 0
  ds_read_b64_tr_b16 v[234:235], v186 offset:10240
  v_mfma_f32_16x16x32_bf16 v[12:15], v[196:199], v[40:43], 0
  ds_read_b64_tr_b16 v[236:237], v187 offset:8192
  v_mfma_f32_16x16x32_bf16 v[8:11], v[192:195], v[40:43], 0
  ds_read_b64_tr_b16 v[238:239], v187 offset:10240
  buffer_load_dwordx4 v[80:83], v2, s[12:15], s38 offen offset:1024 sc1
  buffer_load_dwordx4 v[84:87], v2, s[12:15], s39 offen offset:1024 sc1
  s_waitcnt lgkmcnt(8)
  s_waitcnt vmcnt(8)
  v_mfma_f32_16x16x32_bf16 v[24:27], v[208:211], v[52:55], v[24:27]
  ds_read_b64_tr_b16 v[192:193], v184 offset:12288
  v_mfma_f32_16x16x32_bf16 v[28:31], v[212:215], v[52:55], v[28:31]
  ds_read_b64_tr_b16 v[194:195], v184 offset:14336
  v_mfma_f32_16x16x32_bf16 v[32:35], v[216:219], v[52:55], v[32:35]
  ds_read_b64_tr_b16 v[196:197], v185 offset:12288
  v_mfma_f32_16x16x32_bf16 v[36:39], v[220:223], v[52:55], v[36:39]
  ds_read_b64_tr_b16 v[198:199], v185 offset:14336
  v_mfma_f32_16x16x32_bf16 v[20:23], v[220:223], v[48:51], v[20:23]
  ds_read_b64_tr_b16 v[200:201], v186 offset:12288
  v_mfma_f32_16x16x32_bf16 v[16:19], v[216:219], v[48:51], v[16:19]
  ds_read_b64_tr_b16 v[202:203], v186 offset:14336
  v_mfma_f32_16x16x32_bf16 v[12:15], v[212:215], v[48:51], v[12:15]
  ds_read_b64_tr_b16 v[204:205], v187 offset:12288
  v_mfma_f32_16x16x32_bf16 v[8:11], v[208:211], v[48:51], v[8:11]
  ds_read_b64_tr_b16 v[206:207], v187 offset:14336
  buffer_load_dwordx4 v[88:91], v2, s[12:15], s38 offen offset:2048 sc1
  buffer_load_dwordx4 v[92:95], v2, s[12:15], s39 offen offset:2048 sc1
  s_waitcnt lgkmcnt(8)
  s_waitcnt vmcnt(8)
  v_mfma_f32_16x16x32_bf16 v[24:27], v[224:227], v[60:63], v[24:27]
  ds_read_b64_tr_b16 v[208:209], v184 offset:16384
  v_mfma_f32_16x16x32_bf16 v[28:31], v[228:231], v[60:63], v[28:31]
  ds_read_b64_tr_b16 v[210:211], v184 offset:18432
  v_mfma_f32_16x16x32_bf16 v[32:35], v[232:235], v[60:63], v[32:35]
  ds_read_b64_tr_b16 v[212:213], v185 offset:16384
  v_mfma_f32_16x16x32_bf16 v[36:39], v[236:239], v[60:63], v[36:39]
  ds_read_b64_tr_b16 v[214:215], v185 offset:18432
  v_mfma_f32_16x16x32_bf16 v[20:23], v[236:239], v[56:59], v[20:23]
  ds_read_b64_tr_b16 v[216:217], v186 offset:16384
  v_mfma_f32_16x16x32_bf16 v[16:19], v[232:235], v[56:59], v[16:19]
  ds_read_b64_tr_b16 v[218:219], v186 offset:18432
  v_mfma_f32_16x16x32_bf16 v[12:15], v[228:231], v[56:59], v[12:15]
  ds_read_b64_tr_b16 v[220:221], v187 offset:16384
  v_mfma_f32_16x16x32_bf16 v[8:11], v[224:227], v[56:59], v[8:11]
  ds_read_b64_tr_b16 v[222:223], v187 offset:18432
  buffer_load_dwordx4 v[96:99], v2, s[12:15], s38 offen offset:3072 sc1
  buffer_load_dwordx4 v[100:103], v2, s[12:15], s39 offen offset:3072 sc1
  s_waitcnt lgkmcnt(8)
  s_waitcnt vmcnt(8)
  v_mfma_f32_16x16x32_bf16 v[24:27], v[192:195], v[68:71], v[24:27]
  ds_read_b64_tr_b16 v[224:225], v184 offset:20480
  v_mfma_f32_16x16x32_bf16 v[28:31], v[196:199], v[68:71], v[28:31]
  ds_read_b64_tr_b16 v[226:227], v184 offset:22528
  v_mfma_f32_16x16x32_bf16 v[32:35], v[200:203], v[68:71], v[32:35]
  ds_read_b64_tr_b16 v[228:229], v185 offset:20480
  v_mfma_f32_16x16x32_bf16 v[36:39], v[204:207], v[68:71], v[36:39]
  ds_read_b64_tr_b16 v[230:231], v185 offset:22528
  v_mfma_f32_16x16x32_bf16 v[20:23], v[204:207], v[64:67], v[20:23]
  ds_read_b64_tr_b16 v[232:233], v186 offset:20480
  v_mfma_f32_16x16x32_bf16 v[16:19], v[200:203], v[64:67], v[16:19]
  ds_read_b64_tr_b16 v[234:235], v186 offset:22528
  v_mfma_f32_16x16x32_bf16 v[12:15], v[196:199], v[64:67], v[12:15]
  ds_read_b64_tr_b16 v[236:237], v187 offset:20480
  v_mfma_f32_16x16x32_bf16 v[8:11], v[192:195], v[64:67], v[8:11]
  ds_read_b64_tr_b16 v[238:239], v187 offset:22528
  buffer_load_dwordx2 v[240:241], v182, s[12:15], 0 offen sc1
  s_add_u32 s38, s32, 8192
  s_add_u32 s39, s33, 8192
  buffer_load_dwordx4 v[104:107], v2, s[12:15], s38 offen offset:0 sc1
  buffer_load_dwordx4 v[108:111], v2, s[12:15], s39 offen offset:0 sc1
  s_waitcnt lgkmcnt(8)
  s_waitcnt vmcnt(9)
  v_mfma_f32_16x16x32_bf16 v[24:27], v[208:211], v[76:79], v[24:27]
  ds_read_b64_tr_b16 v[192:193], v184 offset:24576
  v_mfma_f32_16x16x32_bf16 v[28:31], v[212:215], v[76:79], v[28:31]
  ds_read_b64_tr_b16 v[194:195], v184 offset:26624
  v_mfma_f32_16x16x32_bf16 v[32:35], v[216:219], v[76:79], v[32:35]
  ds_read_b64_tr_b16 v[196:197], v185 offset:24576
  v_mfma_f32_16x16x32_bf16 v[36:39], v[220:223], v[76:79], v[36:39]
  ds_read_b64_tr_b16 v[198:199], v185 offset:26624
  v_mfma_f32_16x16x32_bf16 v[20:23], v[220:223], v[72:75], v[20:23]
  ds_read_b64_tr_b16 v[200:201], v186 offset:24576
  v_mfma_f32_16x16x32_bf16 v[16:19], v[216:219], v[72:75], v[16:19]
  ds_read_b64_tr_b16 v[202:203], v186 offset:26624
  v_mfma_f32_16x16x32_bf16 v[12:15], v[212:215], v[72:75], v[12:15]
  ds_read_b64_tr_b16 v[204:205], v187 offset:24576
  v_mfma_f32_16x16x32_bf16 v[8:11], v[208:211], v[72:75], v[8:11]
  ds_read_b64_tr_b16 v[206:207], v187 offset:26624
  buffer_load_dwordx4 v[112:115], v2, s[12:15], s38 offen offset:1024 sc1
  buffer_load_dwordx4 v[116:119], v2, s[12:15], s39 offen offset:1024 sc1
  s_waitcnt lgkmcnt(8)
  s_waitcnt vmcnt(9)
  v_mfma_f32_16x16x32_bf16 v[24:27], v[224:227], v[84:87], v[24:27]
  ds_read_b64_tr_b16 v[208:209], v184 offset:28672
  v_mfma_f32_16x16x32_bf16 v[28:31], v[228:231], v[84:87], v[28:31]
  ds_read_b64_tr_b16 v[210:211], v184 offset:30720
  v_mfma_f32_16x16x32_bf16 v[32:35], v[232:235], v[84:87], v[32:35]
  ds_read_b64_tr_b16 v[212:213], v185 offset:28672
  v_mfma_f32_16x16x32_bf16 v[36:39], v[236:239], v[84:87], v[36:39]
  ds_read_b64_tr_b16 v[214:215], v185 offset:30720
  v_mfma_f32_16x16x32_bf16 v[20:23], v[236:239], v[80:83], v[20:23]
  ds_read_b64_tr_b16 v[216:217], v186 offset:28672
  v_mfma_f32_16x16x32_bf16 v[16:19], v[232:235], v[80:83], v[16:19]
  ds_read_b64_tr_b16 v[218:219], v186 offset:30720
  v_mfma_f32_16x16x32_bf16 v[12:15], v[228:231], v[80:83], v[12:15]
  ds_read_b64_tr_b16 v[220:221], v187 offset:28672
  v_mfma_f32_16x16x32_bf16 v[8:11], v[224:227], v[80:83], v[8:11]
  ds_read_b64_tr_b16 v[222:223], v187 offset:30720
  buffer_load_dwordx4 v[120:123], v2, s[12:15], s38 offen offset:2048 sc1
  buffer_load_dwordx4 v[124:127], v2, s[12:15], s39 offen offset:2048 sc1
  s_waitcnt lgkmcnt(8)
  s_waitcnt vmcnt(9)
  v_mfma_f32_16x16x32_bf16 v[24:27], v[192:195], v[92:95], v[24:27]
  ds_read_b64_tr_b16 v[224:225], v184 offset:32768
  v_mfma_f32_16x16x32_bf16 v[28:31], v[196:199], v[92:95], v[28:31]
  ds_read_b64_tr_b16 v[226:227], v184 offset:34816
  v_mfma_f32_16x16x32_bf16 v[32:35], v[200:203], v[92:95], v[32:35]
  ds_read_b64_tr_b16 v[228:229], v185 offset:32768
  v_mfma_f32_16x16x32_bf16 v[36:39], v[204:207], v[92:95], v[36:39]
  ds_read_b64_tr_b16 v[230:231], v185 offset:34816
  v_mfma_f32_16x16x32_bf16 v[20:23], v[204:207], v[88:91], v[20:23]
  ds_read_b64_tr_b16 v[232:233], v186 offset:32768
  v_mfma_f32_16x16x32_bf16 v[16:19], v[200:203], v[88:91], v[16:19]
  ds_read_b64_tr_b16 v[234:235], v186 offset:34816
  v_mfma_f32_16x16x32_bf16 v[12:15], v[196:199], v[88:91], v[12:15]
  ds_read_b64_tr_b16 v[236:237], v187 offset:32768
  v_mfma_f32_16x16x32_bf16 v[8:11], v[192:195], v[88:91], v[8:11]
  ds_read_b64_tr_b16 v[238:239], v187 offset:34816
  buffer_load_dwordx4 v[128:131], v2, s[12:15], s38 offen offset:3072 sc1
  buffer_load_dwordx4 v[132:135], v2, s[12:15], s39 offen offset:3072 sc1
  s_waitcnt lgkmcnt(8)
  s_waitcnt vmcnt(9)
  v_mfma_f32_16x16x32_bf16 v[24:27], v[208:211], v[100:103], v[24:27]
  ds_read_b64_tr_b16 v[192:193], v184 offset:36864
  v_mfma_f32_16x16x32_bf16 v[28:31], v[212:215], v[100:103], v[28:31]
  ds_read_b64_tr_b16 v[194:195], v184 offset:38912
  v_mfma_f32_16x16x32_bf16 v[32:35], v[216:219], v[100:103], v[32:35]
  ds_read_b64_tr_b16 v[196:197], v185 offset:36864
  v_mfma_f32_16x16x32_bf16 v[36:39], v[220:223], v[100:103], v[36:39]
  ds_read_b64_tr_b16 v[198:199], v185 offset:38912
  v_mfma_f32_16x16x32_bf16 v[20:23], v[220:223], v[96:99], v[20:23]
  ds_read_b64_tr_b16 v[200:201], v186 offset:36864
  v_mfma_f32_16x16x32_bf16 v[16:19], v[216:219], v[96:99], v[16:19]
  ds_read_b64_tr_b16 v[202:203], v186 offset:38912
  v_mfma_f32_16x16x32_bf16 v[12:15], v[212:215], v[96:99], v[12:15]
  ds_read_b64_tr_b16 v[204:205], v187 offset:36864
  v_mfma_f32_16x16x32_bf16 v[8:11], v[208:211], v[96:99], v[8:11]
  ds_read_b64_tr_b16 v[206:207], v187 offset:38912
  s_add_u32 s38, s32, 12288
  s_add_u32 s39, s33, 12288
  buffer_load_dwordx4 v[136:139], v2, s[12:15], s38 offen offset:0 sc1
  buffer_load_dwordx4 v[140:143], v2, s[12:15], s39 offen offset:0 sc1
  s_waitcnt lgkmcnt(8)
  s_waitcnt vmcnt(8)
  v_mfma_f32_16x16x32_bf16 v[24:27], v[224:227], v[108:111], v[24:27]
  ds_read_b64_tr_b16 v[208:209], v188 offset:0
  v_mfma_f32_16x16x32_bf16 v[28:31], v[228:231], v[108:111], v[28:31]
  ds_read_b64_tr_b16 v[210:211], v188 offset:2048
  v_mfma_f32_16x16x32_bf16 v[32:35], v[232:235], v[108:111], v[32:35]
  ds_read_b64_tr_b16 v[212:213], v189 offset:0
  v_mfma_f32_16x16x32_bf16 v[36:39], v[236:239], v[108:111], v[36:39]
  ds_read_b64_tr_b16 v[214:215], v189 offset:2048
  v_mfma_f32_16x16x32_bf16 v[20:23], v[236:239], v[104:107], v[20:23]
  ds_read_b64_tr_b16 v[216:217], v190 offset:0
  v_mfma_f32_16x16x32_bf16 v[16:19], v[232:235], v[104:107], v[16:19]
  ds_read_b64_tr_b16 v[218:219], v190 offset:2048
  v_mfma_f32_16x16x32_bf16 v[12:15], v[228:231], v[104:107], v[12:15]
  ds_read_b64_tr_b16 v[220:221], v191 offset:0
  v_mfma_f32_16x16x32_bf16 v[8:11], v[224:227], v[104:107], v[8:11]
  ds_read_b64_tr_b16 v[222:223], v191 offset:2048
  buffer_load_dwordx4 v[144:147], v2, s[12:15], s38 offen offset:1024 sc1
  buffer_load_dwordx4 v[148:151], v2, s[12:15], s39 offen offset:1024 sc1
  s_waitcnt vmcnt(12)
  s_mov_b32 s58, 0
  s_and_b32 s3, s24, 3
  s_cmp_lg_u32 s3, 0
  s_cbranch_scc1 L_bf_49
L_bp_47:
  v_cmp_ne_u64 vcc, s[96:97], v[240:241]
  s_add_u32 s58, s58, 1
  s_cmp_ge_u32 s58, 4194304
  s_cbranch_scc1 L_bo_48
  s_nop 3
  s_cbranch_vccz L_bo_48
  s_sleep 2
  buffer_load_dwordx2 v[240:241], v182, s[12:15], 0 offen sc1
  s_waitcnt vmcnt(0)
  s_branch L_bp_47
L_bo_48:
  ds_write_b32 v180, v183 offset:92
  s_branch L_be_50
L_bf_49:
  v_cmp_ne_u64 vcc, s[96:97], v[240:241]
  s_nop 4
  s_cbranch_vccz L_be_50
  s_mov_b32 s58, 0
L_spin_51:
  ds_read_b32 v240, v180 offset:92
  s_waitcnt lgkmcnt(0)
  v_readfirstlane_b32 s59, v240
  s_add_u32 s58, s58, 1
  s_cmp_eq_u32 s59, 1
  s_cbranch_scc1 L_spun_52
  s_sleep 2
  s_cmp_lt_u32 s58, 4194304
  s_cbranch_scc1 L_spin_51
L_spun_52:
L_be_50:
  s_add_u32 s3, s34, 0
  buffer_load_dwordx2 v[168:169], v5, s[12:15], s3 offen sc1
  s_add_u32 s3, s34, 65536
  buffer_load_dwordx2 v[170:171], v5, s[12:15], s3 offen sc1
  s_add_u32 s3, s34, 131072
  buffer_load_dwordx2 v[172:173], v5, s[12:15], s3 offen sc1
  s_add_u32 s3, s34, 196608
  buffer_load_dwordx2 v[174:175], v5, s[12:15], s3 offen sc1
  buffer_load_dwordx2 v[176:177], v6, s[12:15], s35 offen sc1
  s_waitcnt lgkmcnt(8)
  s_waitcnt vmcnt(13)
  v_mfma_f32_16x16x32_bf16 v[24:27], v[192:195], v[116:119], v[24:27]
  ds_read_b64_tr_b16 v[224:225], v188 offset:4096
  v_mfma_f32_16x16x32_bf16 v[28:31], v[196:199], v[116:119], v[28:31]
  ds_read_b64_tr_b16 v[226:227], v188 offset:6144
  v_mfma_f32_16x16x32_bf16 v[32:35], v[200:203], v[116:119], v[32:35]
  ds_read_b64_tr_b16 v[228:229], v189 offset:4096
  v_mfma_f32_16x16x32_bf16 v[36:39], v[204:207], v[116:119], v[36:39]
  ds_read_b64_tr_b16 v[230:231], v189 offset:6144
  v_mfma_f32_16x16x32_bf16 v[20:23], v[204:207], v[112:115], v[20:23]
  ds_read_b64_tr_b16 v[232:233], v190 offset:4096
  v_mfma_f32_16x16x32_bf16 v[16:19], v[200:203], v[112:115], v[16:19]
  ds_read_b64_tr_b16 v[234:235], v190 offset:6144
  v_mfma_f32_16x16x32_bf16 v[12:15], v[196:199], v[112:115], v[12:15]
  ds_read_b64_tr_b16 v[236:237], v191 offset:4096
  v_mfma_f32_16x16x32_bf16 v[8:11], v[192:195], v[112:115], v[8:11]
  ds_read_b64_tr_b16 v[238:239], v191 offset:6144
  buffer_load_dwordx4 v[152:155], v2, s[12:15], s38 offen offset:2048 sc1
  buffer_load_dwordx4 v[156:159], v2, s[12:15], s39 offen offset:2048 sc1
  s_waitcnt lgkmcnt(8)
  s_waitcnt vmcnt(13)
  v_mfma_f32_16x16x32_bf16 v[24:27], v[208:211], v[124:127], v[24:27]
  ds_read_b64_tr_b16 v[192:193], v188 offset:8192
  v_mfma_f32_16x16x32_bf16 v[28:31], v[212:215], v[124:127], v[28:31]
  ds_read_b64_tr_b16 v[194:195], v188 offset:10240
  v_mfma_f32_16x16x32_bf16 v[32:35], v[216:219], v[124:127], v[32:35]
  ds_read_b64_tr_b16 v[196:197], v189 offset:8192
  v_mfma_f32_16x16x32_bf16 v[36:39], v[220:223], v[124:127], v[36:39]
  ds_read_b64_tr_b16 v[198:199], v189 offset:10240
  v_mfma_f32_16x16x32_bf16 v[20:23], v[220:223], v[120:123], v[20:23]
  ds_read_b64_tr_b16 v[200:201], v190 offset:8192
  v_mfma_f32_16x16x32_bf16 v[16:19], v[216:219], v[120:123], v[16:19]
  ds_read_b64_tr_b16 v[202:203], v190 offset:10240
  v_mfma_f32_16x16x32_bf16 v[12:15], v[212:215], v[120:123], v[12:15]
  ds_read_b64_tr_b16 v[204:205], v191 offset:8192
  v_mfma_f32_16x16x32_bf16 v[8:11], v[208:211], v[120:123], v[8:11]
  ds_read_b64_tr_b16 v[206:207], v191 offset:10240
  buffer_load_dwordx4 v[160:163], v2, s[12:15], s38 offen offset:3072 sc1
  buffer_load_dwordx4 v[164:167], v2, s[12:15], s39 offen offset:3072 sc1
  s_waitcnt lgkmcnt(8)
  s_waitcnt vmcnt(13)
  v_mfma_f32_16x16x32_bf16 v[24:27], v[224:227], v[132:135], v[24:27]
  ds_read_b64_tr_b16 v[208:209], v188 offset:12288
  v_mfma_f32_16x16x32_bf16 v[28:31], v[228:231], v[132:135], v[28:31]
  ds_read_b64_tr_b16 v[210:211], v188 offset:14336
  v_mfma_f32_16x16x32_bf16 v[32:35], v[232:235], v[132:135], v[32:35]
  ds_read_b64_tr_b16 v[212:213], v189 offset:12288
  v_mfma_f32_16x16x32_bf16 v[36:39], v[236:239], v[132:135], v[36:39]
  ds_read_b64_tr_b16 v[214:215], v189 offset:14336
  v_mfma_f32_16x16x32_bf16 v[20:23], v[236:239], v[128:131], v[20:23]
  ds_read_b64_tr_b16 v[216:217], v190 offset:12288
  v_mfma_f32_16x16x32_bf16 v[16:19], v[232:235], v[128:131], v[16:19]
  ds_read_b64_tr_b16 v[218:219], v190 offset:14336
  v_mfma_f32_16x16x32_bf16 v[12:15], v[228:231], v[128:131], v[12:15]
  ds_read_b64_tr_b16 v[220:221], v191 offset:12288
  v_mfma_f32_16x16x32_bf16 v[8:11], v[224:227], v[128:131], v[8:11]
  ds_read_b64_tr_b16 v[222:223], v191 offset:14336
  s_waitcnt lgkmcnt(8)
  s_waitcnt vmcnt(11)
  v_mfma_f32_16x16x32_bf16 v[24:27], v[192:195], v[140:143], v[24:27]
  ds_read_b64_tr_b16 v[224:225], v188 offset:16384
  v_mfma_f32_16x16x32_bf16 v[28:31], v[196:199], v[140:143], v[28:31]
  ds_read_b64_tr_b16 v[226:227], v188 offset:18432
  v_mfma_f32_16x16x32_bf16 v[32:35], v[200:203], v[140:143], v[32:35]
  ds_read_b64_tr_b16 v[228:229], v189 offset:16384
  v_mfma_f32_16x16x32_bf16 v[36:39], v[204:207], v[140:143], v[36:39]
  ds_read_b64_tr_b16 v[230:231], v189 offset:18432
  v_mfma_f32_16x16x32_bf16 v[20:23], v[204:207], v[136:139], v[20:23]
  ds_read_b64_tr_b16 v[232:233], v190 offset:16384
  v_mfma_f32_16x16x32_bf16 v[16:19], v[200:203], v[136:139], v[16:19]
  ds_read_b64_tr_b16 v[234:235], v190 offset:18432
  v_mfma_f32_16x16x32_bf16 v[12:15], v[196:199], v[136:139], v[12:15]
  ds_read_b64_tr_b16 v[236:237], v191 offset:16384
  v_mfma_f32_16x16x32_bf16 v[8:11], v[192:195], v[136:139], v[8:11]
  ds_read_b64_tr_b16 v[238:239], v191 offset:18432
  s_waitcnt lgkmcnt(8)
  s_waitcnt vmcnt(9)
  v_mfma_f32_16x16x32_bf16 v[24:27], v[208:211], v[148:151], v[24:27]
  ds_read_b64_tr_b16 v[192:193], v188 offset:20480
  v_mfma_f32_16x16x32_bf16 v[28:31], v[212:215], v[148:151], v[28:31]
  ds_read_b64_tr_b16 v[194:195], v188 offset:22528
  v_mfma_f32_16x16x32_bf16 v[32:35], v[216:219], v[148:151], v[32:35]
  ds_read_b64_tr_b16 v[196:197], v189 offset:20480
  v_mfma_f32_16x16x32_bf16 v[36:39], v[220:223], v[148:151], v[36:39]
  ds_read_b64_tr_b16 v[198:199], v189 offset:22528
  v_mfma_f32_16x16x32_bf16 v[20:23], v[220:223], v[144:147], v[20:23]
  ds_read_b64_tr_b16 v[200:201], v190 offset:20480
  v_mfma_f32_16x16x32_bf16 v[16:19], v[216:219], v[144:147], v[16:19]
  ds_read_b64_tr_b16 v[202:203], v190 offset:22528
  v_mfma_f32_16x16x32_bf16 v[12:15], v[212:215], v[144:147], v[12:15]
  ds_read_b64_tr_b16 v[204:205], v191 offset:20480
  v_mfma_f32_16x16x32_bf16 v[8:11], v[208:211], v[144:147], v[8:11]
  ds_read_b64_tr_b16 v[206:207], v191 offset:22528
  s_waitcnt lgkmcnt(8)
  s_waitcnt vmcnt(2)
  s_waitcnt vmcnt(4)
  v_mfma_f32_16x16x32_bf16 v[24:27], v[224:227], v[156:159], v[24:27]
  v_lshlrev_b32 v240, 16, v168
  v_and_b32 v241, 0xffff0000, v168
  v_mfma_f32_16x16x32_bf16 v[28:31], v[228:231], v[156:159], v[28:31]
  v_lshlrev_b32 v242, 16, v169
  v_and_b32 v243, 0xffff0000, v169
  v_mfma_f32_16x16x32_bf16 v[32:35], v[232:235], v[156:159], v[32:35]
  v_mul_f32 v240, v240, v177
  v_mul_f32 v241, v241, v177
  v_mfma_f32_16x16x32_bf16 v[36:39], v[236:239], v[156:159], v[36:39]
  v_mul_f32 v242, v242, v177
  v_mul_f32 v243, v243, v177
  v_mfma_f32_16x16x32_bf16 v[20:23], v[236:239], v[152:155], v[20:23]
  v_lshlrev_b32 v244, 16, v170
  v_and_b32 v245, 0xffff0000, v170
  v_mfma_f32_16x16x32_bf16 v[16:19], v[232:235], v[152:155], v[16:19]
  v_lshlrev_b32 v246, 16, v171
  v_and_b32 v247, 0xffff0000, v171
  v_mfma_f32_16x16x32_bf16 v[12:15], v[228:231], v[152:155], v[12:15]
  v_mul_f32 v244, v244, v177
  v_mul_f32 v245, v245, v177
  v_mfma_f32_16x16x32_bf16 v[8:11], v[224:227], v[152:155], v[8:11]
  v_mul_f32 v246, v246, v177
  v_mul_f32 v247, v247, v177
  s_waitcnt lgkmcnt(0)
  s_waitcnt vmcnt(0)
  v_mfma_f32_16x16x32_bf16 v[24:27], v[192:195], v[164:167], v[24:27]
  v_lshlrev_b32 v248, 16, v172
  v_and_b32 v249, 0xffff0000, v172
  v_mfma_f32_16x16x32_bf16 v[28:31], v[196:199], v[164:167], v[28:31]
  v_lshlrev_b32 v250, 16, v173
  v_and_b32 v251, 0xffff0000, v173
  v_mfma_f32_16x16x32_bf16 v[32:35], v[200:203], v[164:167], v[32:35]
  v_mul_f32 v248, v248, v177
  v_mul_f32 v249, v249, v177
  v_mfma_f32_16x16x32_bf16 v[36:39], v[204:207], v[164:167], v[36:39]
  v_mul_f32 v250, v250, v177
  v_mul_f32 v251, v251, v177
  v_mfma_f32_16x16x32_bf16 v[20:23], v[204:207], v[160:163], v[20:23]
  v_lshlrev_b32 v252, 16, v174
  v_and_b32 v253, 0xffff0000, v174
  v_mfma_f32_16x16x32_bf16 v[16:19], v[200:203], v[160:163], v[16:19]
  v_lshlrev_b32 v254, 16, v175
  v_and_b32 v255, 0xffff0000, v175
  v_mfma_f32_16x16x32_bf16 v[12:15], v[196:199], v[160:163], v[12:15]
  v_mul_f32 v252, v252, v177
  v_mul_f32 v253, v253, v177
  v_mfma_f32_16x16x32_bf16 v[8:11], v[192:195], v[160:163], v[8:11]
  v_mul_f32 v254, v254, v177
  v_mul_f32 v255, v255, v177
  s_barrier
  ds_write_b128 v178, v[24:27] offset:0
  ds_write_b128 v178, v[28:31] offset:1024
  ds_write_b128 v178, v[32:35] offset:2048
  ds_write_b128 v178, v[36:39] offset:3072
  s_nop 0
  v_fmac_f32 v240, v8, v176
  v_fmac_f32 v241, v9, v176
  v_fmac_f32 v242, v10, v176
  v_fmac_f32 v243, v11, v176
  v_fmac_f32 v244, v12, v176
  v_fmac_f32 v245, v13, v176
  v_fmac_f32 v246, v14, v176
  v_fmac_f32 v247, v15, v176
  v_fmac_f32 v248, v16, v176
  v_fmac_f32 v249, v17, v176
  v_fmac_f32 v250, v18, v176
  v_fmac_f32 v251, v19, v176
  v_fmac_f32 v252, v20, v176
  v_fmac_f32 v253, v21, v176
  v_fmac_f32 v254, v22, v176
  v_fmac_f32 v255, v23, v176
  s_waitcnt lgkmcnt(0)
  s_barrier
  ds_read_b128 v[40:43], v179 offset:0
  ds_read_b128 v[44:47], v179 offset:1024
  ds_read_b128 v[48:51], v179 offset:2048
  ds_read_b128 v[52:55], v179 offset:3072
  s_lshl_b32 s3, s24, 12
  s_add_u32 s3, s3, 131072
  s_xor_b32 s3, s3, 16384
  v_and_b32 v3, 15, v0
  v_mul_u32_u24 v3, 144, v3
  v_lshrrev_b32 v4, 4, v0
  v_lshl_add_u32 v3, v4, 3, v3
  v_add_u32 v3, s3, v3
  v_lshrrev_b32 v5, 3, v0
  v_and_b32 v6, 7, v0
  v_mul_u32_u24 v4, 144, v5
  v_lshl_add_u32 v4, v6, 4, v4
  v_add_u32 v4, s3, v4
  v_lshlrev_b32 v7, 11, v5
  v_lshl_add_u32 v7, v6, 4, v7
  s_add_u32 s38, s37, 16384
  s_waitcnt lgkmcnt(0)
  v_fmac_f32 v240, v40, v176
  v_fmac_f32 v241, v41, v176
  v_fmac_f32 v242, v42, v176
  v_fmac_f32 v243, v43, v176
  v_cvt_pk_bf16_f32 v64, v240, v241
  v_cvt_pk_bf16_f32 v65, v242, v243
  ds_write_b64 v3, v[64:65] offset:0
  v_fmac_f32 v244, v44, v176
  v_fmac_f32 v245, v45, v176
  v_fmac_f32 v246, v46, v176
  v_fmac_f32 v247, v47, v176
  v_cvt_pk_bf16_f32 v66, v244, v245
  v_cvt_pk_bf16_f32 v67, v246, v247
  ds_write_b64 v3, v[66:67] offset:32
  v_fmac_f32 v248, v48, v176
  v_fmac_f32 v249, v49, v176
  v_fmac_f32 v250, v50, v176
  v_fmac_f32 v251, v51, v176
  v_cvt_pk_bf16_f32 v68, v248, v249
  v_cvt_pk_bf16_f32 v69, v250, v251
  ds_write_b64 v3, v[68:69] offset:64
  v_fmac_f32 v252, v52, v176
  v_fmac_f32 v253, v53, v176
  v_fmac_f32 v254, v54, v176
  v_fmac_f32 v255, v55, v176
  v_cvt_pk_bf16_f32 v70, v252, v253
  v_cvt_pk_bf16_f32 v71, v254, v255
  ds_write_b64 v3, v[70:71] offset:96
  ds_read_b128 v[72:75], v4
  ds_read_b128 v[76:79], v4 offset:1152
  s_waitcnt lgkmcnt(1)
  buffer_store_dwordx4 v[72:75], v7, s[20:23], s37 offen sc1
  s_waitcnt lgkmcnt(0)
  buffer_store_dwordx4 v[76:79], v7, s[20:23], s38 offen sc1
  s_endpgm
L_end:
  s_endpgm
.section .rodata,"a"
.p2align 6
.amdhsa_kernel gated_mix__linear_attn_block__ssm_conv_s4d__prompt_kernel
  .amdhsa_next_free_vgpr 256
  .amdhsa_next_free_sgpr 102
  .amdhsa_accum_offset 256
  .amdhsa_group_segment_fixed_size 0
  .amdhsa_kernarg_size 112
  .amdhsa_user_sgpr_count 2
  .amdhsa_user_sgpr_kernarg_segment_ptr 1
  .amdhsa_system_sgpr_workgroup_id_x 1
.end_amdhsa_kernel
```
